```python
import torch

def _softmax(x, axis=-1):
    return torch.softmax(x, dim=axis)
def _gelu(x):
    return torch.nn.functional.gelu(x, approximate="tanh")
def _silu(x):
    return torch.nn.functional.silu(x)
def _sigmoid(x):
    return torch.sigmoid(x)
def _layernorm(x, axis=-1, eps=1e-5):
    m = x.mean(dim=axis, keepdim=True)
    v = x.var(dim=axis, keepdim=True, unbiased=False)
    return (x - m) / torch.sqrt(v + eps)
def _scatter_add(tgt, idx, src, axis=0):
    return tgt.clone().index_add_(axis, idx, src)
def _segment_sum(src, seg, n):
    out = torch.zeros((n,) + src.shape[1:], dtype=src.dtype)
    return out.index_add_(0, seg, src)
def _pad(x, pw):
    flat = tuple(v for pair in reversed(pw) for v in pair)
    return torch.nn.functional.pad(x, flat)

kernel_name = 'recurrent_scan__compressed_kv_cla__dense_activation_gelu__decode'

def setup_inputs():

    _w = (lambda a: (lambda t: t.to(torch.bfloat16) if t.is_floating_point() else t)(torch.as_tensor(a)))
    def _A_setup():
        B, H, Sq, Sk, D, M = 4, 32, 1, 4096, 128, 512
        Dc = 4 * D
        return {
            "x": _w((lambda *s: torch.randn(*s, dtype=torch.bfloat16) * 0.1)(B, Sq, M)),
            "c_kv": _w((lambda *s: torch.randn(*s, dtype=torch.bfloat16) * 3.2)(B, Sk, Dc)),
            "w_q": _w((lambda *s: torch.randn(*s, dtype=torch.bfloat16) * 0.8)(M, H, D) * (M ** -0.5)),
            "w_uk": _w((lambda *s: torch.randn(*s, dtype=torch.bfloat16) * 0.8)(Dc, H, D) * (Dc ** -0.5)),
            "w_uv": _w((lambda *s: torch.randn(*s, dtype=torch.bfloat16) * 3.2)(Dc, H, D) * (Dc ** -0.5)),
            "w_o": _w((lambda *s: torch.randn(*s, dtype=torch.bfloat16) * 3.2)(H, D, M) * ((H * D) ** -0.5)),
        }
    _A_in = _A_setup()

    def _B_setup():
        B, S, D, F = 4, 1, 512, 1792
        return {
            "x": _w((lambda *s: torch.randn(*s, dtype=torch.bfloat16) * 0.1)(B, S, D)),
            "w1": _w((lambda *s: torch.randn(*s, dtype=torch.bfloat16) * 3.2)(D, F) * (D ** -0.5)),
            "b1": _w((lambda *s: torch.randn(*s, dtype=torch.bfloat16) * 3.2)(F) * 0.01),
            "w2": _w((lambda *s: torch.randn(*s, dtype=torch.bfloat16) * 3.2)(F, D) * (F ** -0.5)),
            "b2": _w((lambda *s: torch.randn(*s, dtype=torch.bfloat16) * 3.2)(D) * 0.01),
        }
    _B_in = _B_setup()

    return {
        "A_x": _A_in["x"],
        "A_c_kv": _A_in["c_kv"],
        "A_w_q": _A_in["w_q"],
        "A_w_uk": _A_in["w_uk"],
        "A_w_uv": _A_in["w_uv"],
        "A_w_o": _A_in["w_o"],
        "B_x": _B_in["x"],
        "B_w1": _B_in["w1"],
        "B_b1": _B_in["b1"],
        "B_w2": _B_in["w2"],
        "B_b2": _B_in["b2"],
    }

def reference(A_x, A_c_kv, A_w_q, A_w_uk, A_w_uv, A_w_o, B_x, B_w1, B_b1, B_w2, B_b2):
    def _A_ref(x, c_kv, w_q, w_uk, w_uv, w_o):
        B, Sq, M = x.shape[0], x.shape[1], x.shape[2]
        Sk = c_kv.shape[1]
        H, D = w_q.shape[1], w_q.shape[2]
        q = torch.einsum("bqm,mhd->bhqd", x, w_q)
        k = torch.einsum("bkc,chd->bhkd", c_kv, w_uk)
        v = torch.einsum("bkc,chd->bhkd", c_kv, w_uv)
        scores = torch.einsum("bhqd,bhkd->bhqk", q, k) * (D ** -0.5)
        off = Sk - Sq
        qi = torch.arange(Sq)[:, None]
        kj = torch.arange(Sk)[None, :]
        cmask = kj <= (qi + off)
        scores = torch.where(cmask[None, None], scores, -1e9)
        p = _softmax(scores, axis=-1)
        ctx = torch.einsum("bhqk,bhkd->bhqd", p, v)
        return torch.einsum("bhqd,hdm->bqm", ctx, w_o)

    def _B_ref(x, w1, b1, w2, b2):
        h = torch.einsum("bsd,df->bsf", x, w1) + b1
        h = _gelu(h)
        return torch.einsum("bsf,fd->bsd", h, w2) + b2

    x = A_x
    xn = _layernorm(x, axis=-1)
    s = _A_ref(xn, A_c_kv, A_w_q, A_w_uk, A_w_uv, A_w_o)
    g = _silu(_B_ref(xn, B_w1, B_b1, B_w2, B_b2))
    return x + s * g
```

```asm
; @launch grid=(256,1,1) block=(512,1,1) lds=163840
.amdgcn_target "amdgcn-amd-amdhsa--gfx950"
.text
.globl recurrent_scan__compressed_kv_cla__dense_activation_gelu__decode_kernel
.p2align 8
.type recurrent_scan__compressed_kv_cla__dense_activation_gelu__decode_kernel,@function
recurrent_scan__compressed_kv_cla__dense_activation_gelu__decode_kernel:
    s_load_dwordx8 s[16:23], s[0:1], 0
    s_load_dwordx4 s[40:43], s[0:1], 96
    s_cmp_ge_u32 s2, 256
    s_cbranch_scc1 Lend
    v_lshrrev_b32 v1, 6, v0
    v_and_b32 v0, 63, v0
    v_readfirstlane_b32 s3, v1
    s_and_b32 s4, s2, 7
    s_lshr_b32 s5, s2, 3
    v_and_b32 v2, 15, v0
    v_lshrrev_b32 v3, 4, v0
    v_lshlrev_b32 v4, 4, v0
    s_cmp_ge_u32 s5, 16
    s_cbranch_scc1 La_entry

    s_and_b32 s86, s3, 3
    s_lshl_b32 s86, s86, 10
    v_add_u32 v5, s86, v4
    s_lshl_b32 s76, s4, 2
    s_lshr_b32 s6, s5, 2
    s_add_u32 s76, s76, s6
    s_and_b32 s77, s5, 3
    v_lshlrev_b32 v6, 1, v3
    v_xor_b32 v6, v6, v2
    v_lshlrev_b32 v6, 4, v6
    v_lshl_add_u32 v10, v3, 13, v6
    v_xor_b32 v11, 128, v10
    s_lshl_b32 s86, s77, 20
    s_lshl_b32 s87, s76, 8
    s_add_u32 s86, s86, s87
    s_lshl_b32 s87, s3, 17
    s_add_u32 s87, s87, s86
    s_lshl_b32 s88, s3, 12
    s_mov_b32 s54, 4194304
    s_mov_b32 s55, 0x20000
    s_mov_b32 s58, 4194304
    s_mov_b32 s59, 0x20000
    s_waitcnt lgkmcnt(0)
    s_mov_b32 s52, s20
    s_mov_b32 s53, s21
    s_mov_b32 s56, s22
    s_mov_b32 s57, s23

    s_add_u32 m0, s88, 0
    s_add_u32 s89, s87, 0
    buffer_load_dwordx4 v10, s[52:55], s89 offen nt lds
    global_load_dwordx4 v[60:63], v5, s[16:17]
    s_add_u32 m0, s88, 1024
    s_add_u32 s89, s87, 32768
    buffer_load_dwordx4 v10, s[52:55], s89 offen nt lds
    s_add_u32 m0, s88, 2048
    s_add_u32 s89, s87, 65536
    buffer_load_dwordx4 v11, s[52:55], s89 offen nt lds
    s_add_u32 m0, s88, 3072
    s_add_u32 s89, s87, 98304
    buffer_load_dwordx4 v11, s[52:55], s89 offen nt lds
    s_branch Lw_role
La_entry:
    s_lshl_b32 s78, s4, 4
    s_add_u32 s78, s78, s5
    s_sub_u32 s78, s78, 16
    s_mov_b32 s50, 16777216
    s_mov_b32 s51, 0x20000
    s_and_b32 s89, s3, 3
    s_lshl_b32 s12, s89, 5
    v_xor_b32 v60, s12, v4
    v_xor_b32 v61, 128, v60
    s_cmp_ge_u32 s3, 4
    s_cbranch_scc1 La_quick

    s_cmp_lg_u32 s3, 0
    s_cbranch_scc1 Latt_role
    s_getpc_b64 s[6:7]
    s_and_b32 s6, s6, 0xffffff00
    s_sub_u32 s86, s5, 16
    s_lshl_b32 s86, s86, 10
    v_lshlrev_b32 v5, 7, v0
    v_add_u32 v5, s86, v5
    s_mov_b64 exec, 0xff
    global_load_dword v6, v5, s[6:7]
    s_mov_b64 exec, -1
    s_branch Latt_role
La_quick:
    s_lshl_b32 s7, s89, 10
    s_lshr_b32 s6, s78, 5
    s_lshl_b32 s6, s6, 22
    s_and_b32 s88, s78, 31
    s_mul_i32 s88, s88, 8192
    s_add_u32 s6, s6, s88
    s_add_u32 s6, s6, s7
    s_waitcnt lgkmcnt(0)
    s_mov_b32 s48, s18
    s_mov_b32 s49, s19
    s_add_u32 m0, s7, 0
    s_add_u32 s88, s6, 0
    buffer_load_dwordx4 v60, s[48:51], s88 offen nt lds
    s_add_u32 m0, s7, 4096
    s_add_u32 s88, s6, 4096
    buffer_load_dwordx4 v61, s[48:51], s88 offen nt lds
    s_add_u32 m0, s7, 8192
    s_add_u32 s88, s6, 262144
    buffer_load_dwordx4 v60, s[48:51], s88 offen nt lds
    s_add_u32 m0, s7, 12288
    s_add_u32 s88, s6, 266240
    buffer_load_dwordx4 v61, s[48:51], s88 offen nt lds
    s_add_u32 m0, s7, 16384
    s_add_u32 s88, s6, 524288
    buffer_load_dwordx4 v60, s[48:51], s88 offen nt lds
    s_add_u32 m0, s7, 20480
    s_add_u32 s88, s6, 528384
    buffer_load_dwordx4 v61, s[48:51], s88 offen nt lds
    s_add_u32 m0, s7, 24576
    s_add_u32 s88, s6, 786432
    buffer_load_dwordx4 v60, s[48:51], s88 offen nt lds
    s_add_u32 m0, s7, 28672
    s_add_u32 s88, s6, 790528
    buffer_load_dwordx4 v61, s[48:51], s88 offen nt lds
    s_add_u32 m0, s7, 32768
    s_add_u32 s88, s6, 1048576
    buffer_load_dwordx4 v60, s[48:51], s88 offen nt lds
    s_add_u32 m0, s7, 36864
    s_add_u32 s88, s6, 1052672
    buffer_load_dwordx4 v61, s[48:51], s88 offen nt lds
    s_branch La_load
Lw_role:
    s_lshl_b32 s79, s4, 4
    s_add_u32 s79, s79, s5
    s_load_dwordx8 s[24:31], s[0:1], 32
    s_load_dwordx8 s[32:39], s[0:1], 64
    s_add_u32 s84, s42, 0
    s_addc_u32 s85, s43, 0
    s_load_dword s80, s[84:85], 0
    s_mov_b32 s96, 0x05040100
    s_mov_b32 s97, 0x07060302
    s_mov_b32 s98, 0x07060501
    s_mov_b32 s99, 0x07060502
    s_mov_b32 s100, 0x07060503
    s_mov_b32 s8, 0x04000c0c
    s_mov_b32 s9, 0x0706000c
    s_mov_b32 s82, 0xfffefffe

    s_mov_b32 s44, s84
    s_mov_b32 s45, s85
    s_mov_b32 s46, 7835648
    s_mov_b32 s47, 0x20000
    s_barrier
    s_add_u32 m0, s88, 32768
    s_add_u32 s89, s87, 0
    buffer_load_dwordx4 v10, s[56:59], s89 offen nt lds
    s_add_u32 m0, s88, 33792
    s_add_u32 s89, s87, 32768
    buffer_load_dwordx4 v11, s[56:59], s89 offen nt lds
    s_add_u32 m0, s88, 34816
    s_add_u32 s89, s87, 65536
    buffer_load_dwordx4 v10, s[56:59], s89 offen nt lds
    s_add_u32 m0, s88, 35840
    s_add_u32 s89, s87, 98304
    buffer_load_dwordx4 v11, s[56:59], s89 offen nt lds
    s_cmp_ge_u32 s3, 4
    s_cbranch_scc1 Lw_noln
    s_waitcnt vmcnt(7)
    v_mov_b32 v8, v60
    v_mov_b32 v9, v61
    v_mov_b32 v10, v62
    v_mov_b32 v11, v63
    v_lshlrev_b32 v32, 16, v8
    v_and_b32 v33, 0xffff0000, v8
    v_lshlrev_b32 v34, 16, v9
    v_and_b32 v35, 0xffff0000, v9
    v_lshlrev_b32 v36, 16, v10
    v_and_b32 v37, 0xffff0000, v10
    v_lshlrev_b32 v38, 16, v11
    v_and_b32 v39, 0xffff0000, v11
    v_add_f32 v40, v32, v33
    v_add_f32 v41, v34, v35
    v_add_f32 v42, v36, v37
    v_add_f32 v43, v38, v39
    v_add_f32 v40, v40, v41
    v_add_f32 v42, v42, v43
    v_add_f32 v40, v40, v42
    s_nop 1
    v_add_f32_dpp v40, v40, v40 quad_perm:[1,0,3,2] row_mask:0xf bank_mask:0xf
    s_nop 1
    v_add_f32_dpp v40, v40, v40 quad_perm:[2,3,0,1] row_mask:0xf bank_mask:0xf
    s_nop 1
    v_add_f32_dpp v40, v40, v40 row_half_mirror row_mask:0xf bank_mask:0xf
    s_nop 1
    v_add_f32_dpp v40, v40, v40 row_mirror row_mask:0xf bank_mask:0xf
    v_mov_b32 v41, v40
    s_nop 1
    v_permlane16_swap_b32 v40, v41
    v_add_f32 v40, v40, v41
    v_mov_b32 v41, v40
    s_nop 1
    v_permlane32_swap_b32 v40, v41
    v_add_f32 v40, v40, v41
    v_mul_f32 v40, 0x3b000000, v40
    v_sub_f32 v44, v32, v40
    v_sub_f32 v45, v33, v40
    v_sub_f32 v46, v34, v40
    v_sub_f32 v47, v35, v40
    v_sub_f32 v48, v36, v40
    v_sub_f32 v49, v37, v40
    v_sub_f32 v50, v38, v40
    v_sub_f32 v51, v39, v40
    v_mul_f32 v42, v44, v44
    v_fmac_f32 v42, v45, v45
    v_fmac_f32 v42, v46, v46
    v_fmac_f32 v42, v47, v47
    v_fmac_f32 v42, v48, v48
    v_fmac_f32 v42, v49, v49
    v_fmac_f32 v42, v50, v50
    v_fmac_f32 v42, v51, v51
    s_nop 1
    v_add_f32_dpp v42, v42, v42 quad_perm:[1,0,3,2] row_mask:0xf bank_mask:0xf
    s_nop 1
    v_add_f32_dpp v42, v42, v42 quad_perm:[2,3,0,1] row_mask:0xf bank_mask:0xf
    s_nop 1
    v_add_f32_dpp v42, v42, v42 row_half_mirror row_mask:0xf bank_mask:0xf
    s_nop 1
    v_add_f32_dpp v42, v42, v42 row_mirror row_mask:0xf bank_mask:0xf
    v_mov_b32 v41, v42
    s_nop 1
    v_permlane16_swap_b32 v42, v41
    v_add_f32 v42, v42, v41
    v_mov_b32 v41, v42
    s_nop 1
    v_permlane32_swap_b32 v42, v41
    v_add_f32 v42, v42, v41
    v_mul_f32 v42, 0x3b000000, v42
    v_cvt_pk_bf16_f32 v40, v40, v40
    v_lshlrev_b32 v40, 16, v40
    v_cvt_pk_bf16_f32 v42, v42, v42
    v_lshlrev_b32 v42, 16, v42
    v_add_f32 v42, 0x3727c5ac, v42
    v_cvt_pk_bf16_f32 v42, v42, v42
    v_lshlrev_b32 v42, 16, v42
    v_sqrt_f32 v42, v42
    s_nop 0
    v_cvt_pk_bf16_f32 v42, v42, v42
    v_lshlrev_b32 v42, 16, v42
    v_rcp_f32 v42, v42
    v_sub_f32 v44, v32, v40
    v_sub_f32 v45, v33, v40
    v_sub_f32 v46, v34, v40
    v_sub_f32 v47, v35, v40
    v_sub_f32 v48, v36, v40
    v_sub_f32 v49, v37, v40
    v_sub_f32 v50, v38, v40
    v_sub_f32 v51, v39, v40
    v_cvt_pk_bf16_f32 v32, v44, v45
    v_cvt_pk_bf16_f32 v33, v46, v47
    v_cvt_pk_bf16_f32 v34, v48, v49
    v_cvt_pk_bf16_f32 v35, v50, v51
    v_lshlrev_b32 v44, 16, v32
    v_and_b32 v45, 0xffff0000, v32
    v_lshlrev_b32 v46, 16, v33
    v_and_b32 v47, 0xffff0000, v33
    v_lshlrev_b32 v48, 16, v34
    v_and_b32 v49, 0xffff0000, v34
    v_lshlrev_b32 v50, 16, v35
    v_and_b32 v51, 0xffff0000, v35
    v_mul_f32 v44, v44, v42
    v_mul_f32 v45, v45, v42
    v_mul_f32 v46, v46, v42
    v_mul_f32 v47, v47, v42
    v_mul_f32 v48, v48, v42
    v_mul_f32 v49, v49, v42
    v_mul_f32 v50, v50, v42
    v_mul_f32 v51, v51, v42
    v_cvt_pk_bf16_f32 v32, v44, v45
    v_cvt_pk_bf16_f32 v33, v46, v47
    v_cvt_pk_bf16_f32 v34, v48, v49
    v_cvt_pk_bf16_f32 v35, v50, v51
    s_mul_i32 s86, s3, 1088
    s_add_u32 s86, s86, 65536
    v_add_u32 v5, s86, v4
    ds_write_b128 v5, v[32:35]

    s_waitcnt lgkmcnt(0)
    s_mov_b32 s60, s24
    s_mov_b32 s61, s25
    s_mov_b32 s62, 4194304
    s_mov_b32 s63, 0x20000
    s_mov_b32 s64, s26
    s_mov_b32 s65, s27
    s_mov_b32 s66, 4194304
    s_mov_b32 s67, 0x20000
    s_mov_b32 s68, s30
    s_mov_b32 s69, s31
    s_mov_b32 s70, 1835008
    s_mov_b32 s71, 0x20000
    s_branch Lw_ln_done
Lw_noln:
    s_waitcnt lgkmcnt(0)
    s_mov_b32 s60, s24
    s_mov_b32 s61, s25
    s_mov_b32 s62, 4194304
    s_mov_b32 s63, 0x20000
    s_mov_b32 s64, s26
    s_mov_b32 s65, s27
    s_mov_b32 s66, 4194304
    s_mov_b32 s67, 0x20000
    s_mov_b32 s68, s30
    s_mov_b32 s69, s31
    s_mov_b32 s70, 1835008
    s_mov_b32 s71, 0x20000
Lw_ln_done:
    s_and_b32 s86, s80, 0x88888888
    s_and_b32 s80, s80, 0x77777777
    s_add_u32 s80, s80, 0x11111111
    s_xor_b32 s80, s80, s86
Lw_q:
    s_lshl_b32 s86, s3, 1
    v_lshrrev_b32 v36, 2, v2
    v_and_b32 v37, 1, v3
    v_lshl_add_u32 v37, v37, 2, v36
    v_lshlrev_b32 v37, 1, v37
    v_xor_b32 v37, s86, v37
    v_bfe_u32 v38, v2, 1, 1
    v_add_u32 v37, v37, v38
    v_lshlrev_b32 v37, 4, v37
    v_and_b32 v38, 1, v2
    v_lshl_add_u32 v37, v38, 3, v37
    v_lshl_add_u32 v36, v3, 3, v36
    v_lshl_add_u32 v13, v36, 8, v37
    v_add_u32 v13, 0, v13

    v_and_b32 v14, 3, v2
    v_mul_u32_u24 v15, 1088, v14
    v_lshl_add_u32 v15, v3, 4, v15
    s_lshl_b32 s86, s77, 8
    s_add_u32 s86, s86, 65536
    v_add_u32 v15, s86, v15
    s_lshl_b32 s86, s76, 13
    s_lshl_b32 s87, s3, 8
    s_add_u32 s86, s86, s87
    s_add_u32 s86, s86, 4096
    s_lshl_b32 s87, s77, 11
    s_add_u32 s87, s87, s86
    v_lshlrev_b32 v76, 4, v2
    v_lshl_add_u32 v76, v3, 11, v76

    s_waitcnt vmcnt(4)
    s_barrier
    ds_read_b128 v[224:227], v15 offset:0
    ds_read_b64_tr_b16 v[52:53], v13 offset:0
    ds_read_b64_tr_b16 v[54:55], v13 offset:1024
    ds_read_b128 v[228:231], v15 offset:64
    ds_read_b64_tr_b16 v[56:57], v13 offset:8192
    ds_read_b64_tr_b16 v[58:59], v13 offset:9216
    ds_read_b128 v[232:235], v15 offset:128
    ds_read_b64_tr_b16 v[60:61], v13 offset:16384
    ds_read_b64_tr_b16 v[62:63], v13 offset:17408
    ds_read_b128 v[236:239], v15 offset:192
    ds_read_b64_tr_b16 v[64:65], v13 offset:24576
    ds_read_b64_tr_b16 v[66:67], v13 offset:25600
    s_waitcnt lgkmcnt(9)
    v_mfma_f32_16x16x32_bf16 v[68:71], v[224:227], v[52:55], 0
    s_waitcnt lgkmcnt(6)
    v_mfma_f32_16x16x32_bf16 v[68:71], v[228:231], v[56:59], v[68:71]
    s_waitcnt lgkmcnt(3)
    v_mfma_f32_16x16x32_bf16 v[68:71], v[232:235], v[60:63], v[68:71]
    s_waitcnt lgkmcnt(0)
    v_mfma_f32_16x16x32_bf16 v[68:71], v[236:239], v[64:67], v[68:71]
    v_mul_u32_u24 v77, 320, v3
    v_lshl_add_u32 v77, v2, 1, v77
    s_lshl_b32 s88, s3, 5
    s_add_u32 s88, s88, 70144
    v_add_u32 v77, s88, v77
    v_mul_u32_u24 v15, 320, v14
    v_lshl_add_u32 v15, v3, 4, v15
    v_add_u32 v15, 70144, v15

    v_perm_b32 v68, v68, v71, s98
    v_perm_b32 v69, v69, v71, s99
    v_perm_b32 v70, v70, v71, s100
    v_mov_b32 v71, s80
    s_mov_b64 exec, 0xffff
    buffer_store_dwordx4 v[68:71], v4, s[44:47], s87 offen sc1
    s_mov_b64 exec, -1
    v_and_b32 v12, 7, v2
    v_lshlrev_b32 v12, 1, v12
    v_xor_b32 v12, v12, v3
    v_lshlrev_b32 v12, 4, v12
    v_lshl_add_u32 v12, v2, 8, v12
    s_lshl_b32 s88, s3, 12
    s_add_u32 s88, s88, 32768
    v_add_u32 v12, s88, v12
    v_and_b32 v30, 3, v0
    v_lshlrev_b32 v30, 2, v30
    v_mov_b32 v32, s80
    v_lshrrev_b32 v31, v30, v32
    v_bfe_u32 v240, v31, 0, 1
    v_xor_b32 v32, 1, v240
    v_lshl_or_b32 v240, v32, 16, v240
    v_bfe_u32 v241, v31, 1, 1
    v_xor_b32 v32, 1, v241
    v_lshl_or_b32 v241, v32, 16, v241
    v_bfe_u32 v242, v31, 2, 1
    v_xor_b32 v32, 1, v242
    v_lshl_or_b32 v242, v32, 16, v242
    v_bfe_u32 v243, v31, 3, 1
    v_xor_b32 v32, 1, v243
    v_lshl_or_b32 v243, v32, 16, v243
    s_and_b32 s88, s76, 3
    s_lshl_b32 s88, s88, 3
    s_lshr_b32 s88, 0x1111000, s88
    s_and_b32 s88, s88, 31
    s_lshr_b32 s78, s76, 2
    s_lshl_b32 s78, s78, 1
    s_add_u32 s78, s78, s88
    s_and_b32 s88, s3, 1
    s_lshl_b32 s88, s88, 3
    v_lshlrev_b32 v30, 1, v3
    v_add_u32 v30, s88, v30
    v_lshrrev_b32_e64 v30, v30, s80
    v_and_b32 v31, 1, v30
    v_bfe_u32 v30, v30, 1, 1
    v_lshlrev_b32 v244, 16, v31
    v_xor_b32 v245, 0x10000, v244
    v_lshlrev_b32 v246, 16, v30
    v_xor_b32 v247, 0x10000, v246
    v_lshlrev_b32 v36, 8, v14
    v_lshl_add_u32 v36, v3, 3, v36
    s_lshl_b32 s88, s3, 5
    s_add_u32 s88, s88, 71680
    v_add_u32 v36, s88, v36
    v_lshlrev_b32 v37, 15, v3
    v_lshl_add_u32 v37, v2, 4, v37
    v_add_u32 v38, 71680, v4

    s_waitcnt vmcnt(0)
    s_mov_b32 s90, 0
    buffer_load_dwordx4 v[44:47], v76, s[44:47], s86 offen offset:0 sc1
    v_xor_b32 v13, 0, v12
    ds_read_b128 v[16:19], v13
    v_xor_b32 v13, 64, v12
    ds_read_b128 v[20:23], v13
    v_xor_b32 v13, 128, v12
    ds_read_b128 v[24:27], v13
    v_xor_b32 v13, 192, v12
    ds_read_b128 v[28:31], v13
    s_waitcnt vmcnt(0)
    s_branch Lgf_3
Lg_1:
    buffer_load_dwordx4 v[44:47], v76, s[44:47], s86 offen offset:0 sc1
    s_waitcnt vmcnt(0)
Lgf_3:
    v_cmp_ne_u32 vcc, s80, v47
    s_cbranch_vccz Lgd_2
    s_add_u32 s90, s90, 1
    s_cmp_lt_u32 s90, 40000
    s_cbranch_scc1 Lg_1
Lgd_2:
    v_perm_b32 v47, v46, v45, s8
    v_perm_b32 v47, v47, v44, s9
    s_nop 0
    v_permlane32_swap_b32 v44, v46
    v_permlane32_swap_b32 v45, v47
    v_add_f32 v44, v44, v46
    v_add_f32 v45, v45, v47
    s_nop 1
    v_permlane16_swap_b32 v44, v45
    v_add_f32 v44, v44, v45
    v_cvt_pk_bf16_f32 v44, v44, v44
    ds_write_b16 v77, v44
    s_waitcnt lgkmcnt(0)
    s_barrier
    ds_read_b128 v[44:47], v15 offset:0
    ds_read_b128 v[48:51], v15 offset:64
    ds_read_b128 v[52:55], v15 offset:128
    ds_read_b128 v[56:59], v15 offset:192
    v_cmp_gt_u32 vcc, 4, v2
    s_mov_b32 s87, 0x3e0293ee
    s_waitcnt lgkmcnt(3)
    v_mfma_f32_16x16x32_bf16 v[68:71], v[16:19], v[44:47], 0
    s_waitcnt lgkmcnt(2)
    v_mfma_f32_16x16x32_bf16 v[68:71], v[20:23], v[48:51], v[68:71]
    s_waitcnt lgkmcnt(1)
    v_mfma_f32_16x16x32_bf16 v[68:71], v[24:27], v[52:55], v[68:71]
    s_waitcnt lgkmcnt(0)
    v_mfma_f32_16x16x32_bf16 v[68:71], v[28:31], v[56:59], v[68:71]
    s_lshl_b32 s86, s78, 10
    s_lshl_b32 s88, s77, 8
    s_add_u32 s86, s86, s88
    s_add_u32 s86, s86, 266240
    s_nop 3
    v_mul_f32 v68, s87, v68
    v_mul_f32 v69, s87, v69
    v_mul_f32 v70, s87, v70
    v_mul_f32 v71, s87, v71
    s_mov_b32 s87, 0xfffe0000
    v_add_u32 v68, v68, v245
    v_add_u32 v69, v69, v244
    v_add_u32 v70, v70, v247
    v_add_u32 v71, v71, v246
    v_and_or_b32 v68, v68, s87, v244
    v_and_or_b32 v69, v69, s87, v245
    v_and_or_b32 v70, v70, s87, v246
    v_and_or_b32 v71, v71, s87, v247
    v_perm_b32 v68, v69, v68, s97
    v_perm_b32 v69, v71, v70, s97
    s_mov_b64 exec, vcc
    ds_write_b64 v36, v[68:69]
    s_mov_b64 exec, -1
    s_waitcnt lgkmcnt(0)

    s_barrier
    s_cmp_lg_u32 s3, 0
    s_cbranch_scc1 Lw_nopub
Lw_pub:
    ds_read_b128 v[44:47], v38
    s_waitcnt lgkmcnt(0)
    buffer_store_dwordx4 v[44:47], v37, s[44:47], s86 offen sc1
Lw_nopub:
    s_barrier
    s_and_b32 s86, s76, 3
    s_sub_u32 s86, s86, 2
    s_and_b32 s86, s86, 3
    s_lshr_b32 s81, s76, 2
    s_lshl_b32 s81, s81, 1
    s_add_u32 s81, s81, s86
    s_cmp_lt_u32 s86, 2
    s_cselect_b32 s81, s81, -1
    s_cmp_lt_u32 s81, 14
    s_cselect_b32 s81, s81, -1
    s_add_u32 s86, s76, 1
    s_and_b32 s86, s86, 3
    s_and_b32 s76, s76, 28
    s_add_u32 s76, s76, s86
    s_add_u32 s4, s77, 3
    s_and_b32 s4, s4, 3
    s_lshl_b32 s4, s4, 15
    s_cmp_eq_u32 s81, -1
    s_cbranch_scc1 Lw_nw1
    s_mov_b32 s89, 3584
    v_mul_u32_u24 v10, 3584, v3
    v_add_u32 v10, v10, v6
    v_xor_b32 v11, 128, v6
    v_mad_u32_u24 v11, v3, s89, v11
    s_lshl_b32 s87, s77, 3
    s_add_u32 s87, s87, s3
    s_mul_i32 s87, s87, 57344
    s_lshl_b32 s86, s81, 8
    s_add_u32 s87, s87, s86
    s_lshl_b32 s88, s3, 12
    s_add_u32 s88, s88, s4
    s_add_u32 m0, s88, 0
    s_add_u32 s89, s87, 0
    buffer_load_dwordx4 v10, s[68:71], s89 offen nt lds
    s_add_u32 m0, s88, 1024
    s_add_u32 s89, s87, 14336
    buffer_load_dwordx4 v10, s[68:71], s89 offen nt lds
    s_add_u32 m0, s88, 2048
    s_add_u32 s89, s87, 28672
    buffer_load_dwordx4 v11, s[68:71], s89 offen nt lds
    s_add_u32 m0, s88, 3072
    s_add_u32 s89, s87, 43008
    buffer_load_dwordx4 v11, s[68:71], s89 offen nt lds
Lw_nw1:
    v_lshl_add_u32 v10, v3, 17, v6
    v_xor_b32 v11, 128, v10
    s_lshl_b32 s86, s77, 20
    s_lshl_b32 s87, s76, 8
    s_add_u32 s86, s86, s87
    s_lshl_b32 s87, s3, 14
    s_add_u32 s86, s86, s87
    s_lshl_b32 s88, s3, 12
    s_and_b32 s87, s3, 1
    s_lshl_b32 s87, s87, 7
    v_xor_b32 v16, s87, v4
    v_xor_b32 v17, 32, v16
    v_xor_b32 v18, 64, v16
    v_xor_b32 v19, 96, v16

    s_add_u32 m0, s88, 131072
    s_add_u32 s89, s86, 0
    buffer_load_dwordx4 v10, s[60:63], s89 offen nt lds
    s_add_u32 m0, s88, 132096
    s_add_u32 s89, s86, 524288
    buffer_load_dwordx4 v10, s[60:63], s89 offen nt lds
    s_add_u32 m0, s88, 133120
    s_add_u32 s89, s86, 8192
    buffer_load_dwordx4 v11, s[60:63], s89 offen nt lds
    s_add_u32 m0, s88, 134144
    s_add_u32 s89, s86, 532480
    buffer_load_dwordx4 v11, s[60:63], s89 offen nt lds
    s_add_u32 s87, s77, 0
    s_and_b32 s87, s87, 3
    s_lshl_b32 s87, s87, 15
    s_add_u32 s87, s87, s88
    s_lshl_b32 s5, s76, 17
    s_add_u32 s5, s5, s87
    s_add_u32 m0, s87, 0
    s_add_u32 s89, s5, 0
    buffer_load_dwordx4 v16, s[64:67], s89 offen lds
    s_add_u32 m0, s87, 1024
    s_add_u32 s89, s5, 1024
    buffer_load_dwordx4 v17, s[64:67], s89 offen lds
    s_add_u32 m0, s87, 2048
    s_add_u32 s89, s5, 2048
    buffer_load_dwordx4 v18, s[64:67], s89 offen lds
    s_add_u32 m0, s87, 3072
    s_add_u32 s89, s5, 3072
    buffer_load_dwordx4 v19, s[64:67], s89 offen lds
    s_cmp_eq_u32 s81, -1
    s_cbranch_scc1 Lw_nof1
    s_lshl_b32 s87, s3, 1
    v_lshrrev_b32 v50, 2, v2
    v_and_b32 v51, 1, v3
    v_lshl_add_u32 v51, v51, 2, v50
    v_lshlrev_b32 v51, 1, v51
    v_xor_b32 v51, s87, v51
    v_bfe_u32 v52, v2, 1, 1
    v_add_u32 v51, v51, v52
    v_lshlrev_b32 v51, 4, v51
    v_and_b32 v52, 1, v2
    v_lshl_add_u32 v51, v52, 3, v51
    v_lshl_add_u32 v50, v3, 3, v50
    v_lshl_add_u32 v53, v50, 8, v51
    v_add_u32 v53, 0, v53

    v_add_u32 v53, s4, v53
    s_lshl_b32 s6, s81, 13
    s_lshl_b32 s87, s77, 11
    s_add_u32 s6, s6, s87
    s_lshl_b32 s87, s3, 8
    s_add_u32 s6, s6, s87
    s_add_u32 s6, s6, 561152
    s_waitcnt vmcnt(8)
    s_barrier
    ds_read_b64_tr_b16 v[64:65], v53 offset:0
    ds_read_b64_tr_b16 v[66:67], v53 offset:1024
    ds_read_b64_tr_b16 v[68:69], v53 offset:8192
    ds_read_b64_tr_b16 v[70:71], v53 offset:9216
    ds_read_b64_tr_b16 v[72:73], v53 offset:16384
    ds_read_b64_tr_b16 v[74:75], v53 offset:17408
    ds_read_b64_tr_b16 v[76:77], v53 offset:24576
    ds_read_b64_tr_b16 v[78:79], v53 offset:25600
    s_waitcnt lgkmcnt(6)
    v_mfma_f32_16x16x32_bf16 v[80:83], v[224:227], v[64:67], 0
    s_waitcnt lgkmcnt(4)
    v_mfma_f32_16x16x32_bf16 v[80:83], v[228:231], v[68:71], v[80:83]
    s_waitcnt lgkmcnt(2)
    v_mfma_f32_16x16x32_bf16 v[80:83], v[232:235], v[72:75], v[80:83]
    s_waitcnt lgkmcnt(0)
    v_mfma_f32_16x16x32_bf16 v[80:83], v[236:239], v[76:79], v[80:83]
    s_nop 7
    v_perm_b32 v80, v80, v83, s98
    v_perm_b32 v81, v81, v83, s99
    v_perm_b32 v82, v82, v83, s100
    v_mov_b32 v83, s80
    s_mov_b64 exec, 0xffff
    buffer_store_dwordx4 v[80:83], v4, s[44:47], s6 offen sc1
    s_mov_b64 exec, -1
Lw_nof1:
    s_add_u32 s87, s77, 1
    s_and_b32 s87, s87, 3
    s_lshl_b32 s87, s87, 15
    s_add_u32 s87, s87, s88
    s_lshl_b32 s5, s76, 17
    s_add_u32 s5, s5, s87
    s_add_u32 m0, s87, 0
    s_add_u32 s89, s5, 0
    buffer_load_dwordx4 v16, s[64:67], s89 offen lds
    s_add_u32 m0, s87, 1024
    s_add_u32 s89, s5, 1024
    buffer_load_dwordx4 v17, s[64:67], s89 offen lds
    s_add_u32 m0, s87, 2048
    s_add_u32 s89, s5, 2048
    buffer_load_dwordx4 v18, s[64:67], s89 offen lds
    s_add_u32 m0, s87, 3072
    s_add_u32 s89, s5, 3072
    buffer_load_dwordx4 v19, s[64:67], s89 offen lds
    s_add_u32 s87, s77, 2
    s_and_b32 s87, s87, 3
    s_lshl_b32 s87, s87, 15
    s_add_u32 s87, s87, s88
    s_lshl_b32 s5, s76, 17
    s_add_u32 s5, s5, s87
    s_add_u32 m0, s87, 0
    s_add_u32 s89, s5, 0
    buffer_load_dwordx4 v16, s[64:67], s89 offen lds
    s_add_u32 m0, s87, 1024
    s_add_u32 s89, s5, 1024
    buffer_load_dwordx4 v17, s[64:67], s89 offen lds
    s_add_u32 m0, s87, 2048
    s_add_u32 s89, s5, 2048
    buffer_load_dwordx4 v18, s[64:67], s89 offen lds
    s_add_u32 m0, s87, 3072
    s_add_u32 s89, s5, 3072
    buffer_load_dwordx4 v19, s[64:67], s89 offen lds
    s_barrier
    s_add_u32 s87, s77, 3
    s_and_b32 s87, s87, 3
    s_lshl_b32 s87, s87, 15
    s_add_u32 s87, s87, s88
    s_lshl_b32 s5, s76, 17
    s_add_u32 s5, s5, s87
    s_add_u32 m0, s87, 0
    s_add_u32 s89, s5, 0
    buffer_load_dwordx4 v16, s[64:67], s89 offen lds
    s_add_u32 m0, s87, 1024
    s_add_u32 s89, s5, 1024
    buffer_load_dwordx4 v17, s[64:67], s89 offen lds
    s_add_u32 m0, s87, 2048
    s_add_u32 s89, s5, 2048
    buffer_load_dwordx4 v18, s[64:67], s89 offen lds
    s_add_u32 m0, s87, 3072
    s_add_u32 s89, s5, 3072
    buffer_load_dwordx4 v19, s[64:67], s89 offen lds
    s_and_b32 s88, s76, 3
    s_lshl_b32 s88, s88, 3
    s_lshr_b32 s88, 0x1111000, s88
    s_and_b32 s88, s88, 31
    s_lshr_b32 s78, s76, 2
    s_lshl_b32 s78, s78, 1
    s_add_u32 s78, s78, s88
Lw_tail:
    s_lshl_b32 s86, s3, 1
    v_lshrrev_b32 v36, 2, v2
    v_and_b32 v37, 1, v3
    v_lshl_add_u32 v37, v37, 2, v36
    v_lshlrev_b32 v37, 1, v37
    v_xor_b32 v37, s86, v37
    v_bfe_u32 v38, v2, 1, 1
    v_add_u32 v37, v37, v38
    v_lshlrev_b32 v37, 4, v37
    v_and_b32 v38, 1, v2
    v_lshl_add_u32 v37, v38, 3, v37
    v_lshl_add_u32 v36, v3, 3, v36
    v_lshl_add_u32 v13, v36, 8, v37
    v_add_u32 v13, 131072, v13

    v_lshrrev_b32 v28, 2, v2
    v_lshl_add_u32 v28, v3, 2, v28
    v_and_b32 v29, 7, v28
    v_lshlrev_b32 v29, 5, v29
    s_lshl_b32 s86, s3, 7
    v_xor_b32 v29, s86, v29
    v_and_b32 v30, 3, v2
    v_lshl_add_u32 v29, v30, 3, v29
    v_lshl_add_u32 v29, v28, 10, v29

    v_xor_b32 v24, 0, v29
    v_xor_b32 v25, 32, v29
    v_xor_b32 v26, 64, v29
    v_xor_b32 v27, 96, v29
    v_and_b32 v6, 7, v0
    v_lshrrev_b32 v8, 3, v0
    v_lshlrev_b32 v9, 8, v8
    v_lshl_add_u32 v9, v6, 4, v9
    v_lshlrev_b32 v8, 2, v8
    v_lshlrev_b32 v5, 9, v0
    s_and_b32 s88, s3, 3
    s_lshr_b32 s89, s3, 2
    s_mul_i32 s86, s88, 320
    s_lshl_b32 s87, s89, 7
    s_add_u32 s86, s86, s87
    s_add_u32 s86, s86, 131072
    v_lshlrev_b32 v7, 4, v6
    v_lshl_add_u32 v7, v3, 2, v7
    v_add_u32 v7, s86, v7
    v_and_b32 v14, 3, v2
    v_mul_u32_u24 v11, 320, v14
    v_lshl_add_u32 v15, v3, 4, v11
    v_add_u32 v11, 133120, v15
    v_add_u32 v15, 131072, v15
    s_lshr_b32 s86, s3, 1
    s_lshl_b32 s86, s86, 6
    s_and_b32 s87, s3, 1
    s_lshl_b32 s87, s87, 3
    s_add_u32 s86, s86, s87
    v_add_u32 v10, s86, v11
    s_lshl_b32 s5, s78, 4
    s_add_u32 s5, s5, 430080
    s_lshl_b32 s87, s88, 7
    s_add_u32 s87, s87, 135168
    v_add_u32 v8, s87, v8
    s_lshl_b32 s86, s78, 17
    s_lshl_b32 s87, s77, 15
    s_add_u32 s86, s86, s87
    s_lshl_b32 s87, s88, 13
    s_add_u32 s86, s86, s87
    s_lshl_b32 s87, s89, 7
    s_add_u32 s86, s86, s87
    s_add_u32 s86, s86, 3117056
    s_add_u32 s87, s86, 4096
    s_waitcnt vmcnt(0)

    s_barrier
    ds_read_b64_tr_b16 v[96:97], v13 offset:0
    ds_read_b64_tr_b16 v[98:99], v13 offset:1024
    ds_read_b64_tr_b16 v[100:101], v13 offset:8192
    ds_read_b64_tr_b16 v[102:103], v13 offset:9216
    ds_read_b64_tr_b16 v[104:105], v13 offset:16384
    ds_read_b64_tr_b16 v[106:107], v13 offset:17408
    ds_read_b64_tr_b16 v[108:109], v13 offset:24576
    ds_read_b64_tr_b16 v[110:111], v13 offset:25600
    ds_read_b64_tr_b16 v[112:113], v24 offset:0
    ds_read_b64_tr_b16 v[114:115], v24 offset:16384
    ds_read_b64_tr_b16 v[116:117], v25 offset:0
    ds_read_b64_tr_b16 v[118:119], v25 offset:16384
    ds_read_b64_tr_b16 v[120:121], v26 offset:0
    ds_read_b64_tr_b16 v[122:123], v26 offset:16384
    ds_read_b64_tr_b16 v[124:125], v27 offset:0
    ds_read_b64_tr_b16 v[126:127], v27 offset:16384
    ds_read_b64_tr_b16 v[128:129], v24 offset:32768
    ds_read_b64_tr_b16 v[130:131], v24 offset:49152
    ds_read_b64_tr_b16 v[132:133], v25 offset:32768
    ds_read_b64_tr_b16 v[134:135], v25 offset:49152
    ds_read_b64_tr_b16 v[136:137], v26 offset:32768
    ds_read_b64_tr_b16 v[138:139], v26 offset:49152
    ds_read_b64_tr_b16 v[140:141], v27 offset:32768
    ds_read_b64_tr_b16 v[142:143], v27 offset:49152
    v_add_u32 v24, 0x10000, v24
    v_add_u32 v25, 0x10000, v25
    v_add_u32 v26, 0x10000, v26
    v_add_u32 v27, 0x10000, v27
    ds_read_b64_tr_b16 v[144:145], v24 offset:0
    ds_read_b64_tr_b16 v[146:147], v24 offset:16384
    ds_read_b64_tr_b16 v[148:149], v25 offset:0
    ds_read_b64_tr_b16 v[150:151], v25 offset:16384
    ds_read_b64_tr_b16 v[152:153], v26 offset:0
    ds_read_b64_tr_b16 v[154:155], v26 offset:16384
    ds_read_b64_tr_b16 v[156:157], v27 offset:0
    ds_read_b64_tr_b16 v[158:159], v27 offset:16384
    ds_read_b64_tr_b16 v[160:161], v24 offset:32768
    ds_read_b64_tr_b16 v[162:163], v24 offset:49152
    ds_read_b64_tr_b16 v[164:165], v25 offset:32768
    ds_read_b64_tr_b16 v[166:167], v25 offset:49152
    ds_read_b64_tr_b16 v[168:169], v26 offset:32768
    ds_read_b64_tr_b16 v[170:171], v26 offset:49152
    ds_read_b64_tr_b16 v[172:173], v27 offset:32768
    ds_read_b64_tr_b16 v[174:175], v27 offset:49152
    s_waitcnt lgkmcnt(0)
    s_cmp_lg_u32 s3, 0
    s_cbranch_scc1 Lw_h1
Lw_h0:
    s_add_u32 s88, s5, 32768
    s_mov_b32 s90, 0
    buffer_load_dwordx4 v[32:35], v5, s[44:47], s5 offen offset:0 sc1
    buffer_load_dwordx4 v[36:39], v5, s[44:47], s88 offen offset:0 sc1
    s_waitcnt vmcnt(0)
    s_branch Lgf_6
Lg_4:
    buffer_load_dwordx4 v[32:35], v5, s[44:47], s5 offen offset:0 sc1
    buffer_load_dwordx4 v[36:39], v5, s[44:47], s88 offen offset:0 sc1
    s_waitcnt vmcnt(0)
Lgf_6:
    v_cmp_ne_u32 vcc, s80, v34
    v_cmp_ne_u32 s[92:93], s80, v38
    s_or_b64 vcc, vcc, s[92:93]
    s_cbranch_vccz Lgd_5
    s_add_u32 s90, s90, 1
    s_cmp_lt_u32 s90, 40000
    s_cbranch_scc1 Lg_4
Lgd_5:
    s_cmp_lg_u32 s79, 0
    s_cbranch_scc1 Lw_ne
    v_mov_b32 v44, 0
    v_mov_b32 v45, s80
    s_mov_b64 exec, 1
    buffer_store_dword v45, v44, s[44:47], 0 offen sc1
    s_mov_b64 exec, -1
Lw_ne:
    s_lshl_b32 s5, s78, 10
    s_add_u32 s5, s5, 495616
    v_lshlrev_b32 v5, 3, v0
Lw_h1:
    s_barrier
    s_mov_b32 s90, 0
    buffer_load_dwordx4 v[16:19], v9, s[44:47], s86 offen offset:0 sc1
    buffer_load_dwordx4 v[20:23], v9, s[44:47], s86 offen offset:2048 sc1
    buffer_load_dwordx4 v[24:27], v9, s[44:47], s87 offen offset:0 sc1
    buffer_load_dwordx4 v[28:31], v9, s[44:47], s87 offen offset:2048 sc1
    s_cmp_lg_u32 s3, 0
    s_cbranch_scc1 Lwt_10
    buffer_load_dwordx2 v[84:85], v5, s[44:47], s5 offen sc1
    buffer_load_dwordx2 v[88:89], v5, s[44:47], s5 offen offset:512 sc1
    v_mov_b32 v40, v32
    v_mov_b32 v41, v36
    s_nop 1
    v_max_f32_dpp v40, v40, v40 quad_perm:[1,0,3,2] row_mask:0xf bank_mask:0xf
    v_max_f32_dpp v41, v41, v41 quad_perm:[1,0,3,2] row_mask:0xf bank_mask:0xf
    s_nop 1
    v_max_f32_dpp v40, v40, v40 quad_perm:[2,3,0,1] row_mask:0xf bank_mask:0xf
    v_max_f32_dpp v41, v41, v41 quad_perm:[2,3,0,1] row_mask:0xf bank_mask:0xf
    s_nop 1
    v_max_f32_dpp v40, v40, v40 row_half_mirror row_mask:0xf bank_mask:0xf
    v_max_f32_dpp v41, v41, v41 row_half_mirror row_mask:0xf bank_mask:0xf
    s_nop 1
    v_max_f32_dpp v40, v40, v40 row_mirror row_mask:0xf bank_mask:0xf
    v_max_f32_dpp v41, v41, v41 row_mirror row_mask:0xf bank_mask:0xf
    v_mov_b32 v42, v40
    v_mov_b32 v43, v41
    s_nop 1
    v_permlane16_swap_b32 v40, v42
    v_permlane16_swap_b32 v41, v43
    v_max_f32 v40, v40, v42
    v_max_f32 v41, v41, v43
    v_sub_f32 v80, v32, v40
    v_sub_f32 v81, v36, v41
    v_exp_f32 v80, v80
    v_exp_f32 v81, v81
    v_lshlrev_b32 v42, 2, v0
    v_add_u32 v42, 0x20000, v42
    ds_write_b32 v42, v80 offset:4096
    ds_write_b32 v42, v81 offset:4352
    s_waitcnt lgkmcnt(0)
Lwt_10:
    s_barrier
    ds_read_b32 v32, v8 offset:0
    ds_read_b32 v36, v8 offset:32
    ds_read_b32 v40, v8 offset:64
    ds_read_b32 v44, v8 offset:96
    s_waitcnt vmcnt(0)
    s_branch Lgf_9
Lg_7:
    buffer_load_dwordx4 v[16:19], v9, s[44:47], s86 offen offset:0 sc1
    buffer_load_dwordx4 v[20:23], v9, s[44:47], s86 offen offset:2048 sc1
    buffer_load_dwordx4 v[24:27], v9, s[44:47], s87 offen offset:0 sc1
    buffer_load_dwordx4 v[28:31], v9, s[44:47], s87 offen offset:2048 sc1
    s_waitcnt vmcnt(0)
Lgf_9:
    v_xor_b32 v49, v16, v240
    v_bitop3_b32 v49, v49, v17, v241 bitop3:0xf6
    v_bitop3_b32 v49, v49, v18, v242 bitop3:0xf6
    v_bitop3_b32 v49, v49, v19, v243 bitop3:0xf6
    v_bitop3_b32 v49, v49, v20, v240 bitop3:0xf6
    v_bitop3_b32 v49, v49, v21, v241 bitop3:0xf6
    v_bitop3_b32 v49, v49, v22, v242 bitop3:0xf6
    v_bitop3_b32 v49, v49, v23, v243 bitop3:0xf6
    v_bitop3_b32 v49, v49, v24, v240 bitop3:0xf6
    v_bitop3_b32 v49, v49, v25, v241 bitop3:0xf6
    v_bitop3_b32 v49, v49, v26, v242 bitop3:0xf6
    v_bitop3_b32 v49, v49, v27, v243 bitop3:0xf6
    v_bitop3_b32 v49, v49, v28, v240 bitop3:0xf6
    v_bitop3_b32 v49, v49, v29, v241 bitop3:0xf6
    v_bitop3_b32 v49, v49, v30, v242 bitop3:0xf6
    v_bitop3_b32 v49, v49, v31, v243 bitop3:0xf6
    v_and_b32 v49, 0x10001, v49
    v_cmp_ne_u32 vcc, 0, v49
    s_cbranch_vccz Lgd_8
    s_add_u32 s90, s90, 1
    s_cmp_lt_u32 s90, 40000
    s_cbranch_scc1 Lg_7
Lgd_8:
Lw_tail2:
    s_waitcnt lgkmcnt(0)
    v_lshlrev_b32 v50, 16, v16
    v_and_b32 v51, 0xffff0000, v16
    v_lshlrev_b32 v52, 16, v17
    v_and_b32 v53, 0xffff0000, v17
    v_lshlrev_b32 v54, 16, v18
    v_and_b32 v55, 0xffff0000, v18
    v_lshlrev_b32 v56, 16, v19
    v_and_b32 v57, 0xffff0000, v19
    v_mul_f32 v60, v50, v32
    v_mul_f32 v61, v51, v32
    v_mul_f32 v62, v52, v32
    v_mul_f32 v63, v53, v32
    v_mul_f32 v64, v54, v32
    v_mul_f32 v65, v55, v32
    v_mul_f32 v66, v56, v32
    v_mul_f32 v67, v57, v32
    v_lshlrev_b32 v50, 16, v20
    v_and_b32 v51, 0xffff0000, v20
    v_lshlrev_b32 v52, 16, v21
    v_and_b32 v53, 0xffff0000, v21
    v_lshlrev_b32 v54, 16, v22
    v_and_b32 v55, 0xffff0000, v22
    v_lshlrev_b32 v56, 16, v23
    v_and_b32 v57, 0xffff0000, v23
    v_fmac_f32 v60, v50, v36
    v_fmac_f32 v61, v51, v36
    v_fmac_f32 v62, v52, v36
    v_fmac_f32 v63, v53, v36
    v_fmac_f32 v64, v54, v36
    v_fmac_f32 v65, v55, v36
    v_fmac_f32 v66, v56, v36
    v_fmac_f32 v67, v57, v36
    v_lshlrev_b32 v50, 16, v24
    v_and_b32 v51, 0xffff0000, v24
    v_lshlrev_b32 v52, 16, v25
    v_and_b32 v53, 0xffff0000, v25
    v_lshlrev_b32 v54, 16, v26
    v_and_b32 v55, 0xffff0000, v26
    v_lshlrev_b32 v56, 16, v27
    v_and_b32 v57, 0xffff0000, v27
    v_fmac_f32 v60, v50, v40
    v_fmac_f32 v61, v51, v40
    v_fmac_f32 v62, v52, v40
    v_fmac_f32 v63, v53, v40
    v_fmac_f32 v64, v54, v40
    v_fmac_f32 v65, v55, v40
    v_fmac_f32 v66, v56, v40
    v_fmac_f32 v67, v57, v40
    v_lshlrev_b32 v50, 16, v28
    v_and_b32 v51, 0xffff0000, v28
    v_lshlrev_b32 v52, 16, v29
    v_and_b32 v53, 0xffff0000, v29
    v_lshlrev_b32 v54, 16, v30
    v_and_b32 v55, 0xffff0000, v30
    v_lshlrev_b32 v56, 16, v31
    v_and_b32 v57, 0xffff0000, v31
    v_fmac_f32 v60, v50, v44
    v_fmac_f32 v61, v51, v44
    v_fmac_f32 v62, v52, v44
    v_fmac_f32 v63, v53, v44
    v_fmac_f32 v64, v54, v44
    v_fmac_f32 v65, v55, v44
    v_fmac_f32 v66, v56, v44
    v_fmac_f32 v67, v57, v44
    s_nop 0
    v_permlane32_swap_b32 v60, v64
    v_permlane32_swap_b32 v61, v65
    v_permlane32_swap_b32 v62, v66
    v_permlane32_swap_b32 v63, v67
    v_add_f32 v60, v60, v64
    v_add_f32 v61, v61, v65
    v_add_f32 v62, v62, v66
    v_add_f32 v63, v63, v67
    s_nop 0
    v_permlane16_swap_b32 v60, v62
    v_permlane16_swap_b32 v61, v63
    v_add_f32 v60, v60, v62
    v_add_f32 v61, v61, v63
    s_nop 1
    v_add_f32_dpp v60, v60, v60 row_ror:8 row_mask:0xf bank_mask:0xf
    v_add_f32_dpp v61, v61, v61 row_ror:8 row_mask:0xf bank_mask:0xf
    v_cvt_pk_bf16_f32 v60, v60, v61
    ds_write_b32 v7, v60
    s_cmp_lg_u32 s3, 0
    s_cbranch_scc1 Lw_nl2
    s_mov_b32 s90, 0
    s_waitcnt vmcnt(0)
    s_branch Lgf_13
Lg_11:
    buffer_load_dwordx2 v[84:85], v5, s[44:47], s5 offen offset:0 sc1
    buffer_load_dwordx2 v[88:89], v5, s[44:47], s5 offen offset:512 sc1
    s_waitcnt vmcnt(0)
Lgf_13:
    v_cmp_ne_u32 vcc, s80, v85
    v_cmp_ne_u32 s[92:93], s80, v89
    s_or_b64 vcc, vcc, s[92:93]
    s_cbranch_vccz Lgd_12
    s_add_u32 s90, s90, 1
    s_cmp_lt_u32 s90, 40000
    s_cbranch_scc1 Lg_11
Lgd_12:
    v_mul_f32 v40, v80, v84
    v_mul_f32 v41, v81, v88
    s_nop 1
    v_add_f32_dpp v40, v40, v40 quad_perm:[1,0,3,2] row_mask:0xf bank_mask:0xf
    v_add_f32_dpp v41, v41, v41 quad_perm:[1,0,3,2] row_mask:0xf bank_mask:0xf
    s_nop 1
    v_add_f32_dpp v40, v40, v40 quad_perm:[2,3,0,1] row_mask:0xf bank_mask:0xf
    v_add_f32_dpp v41, v41, v41 quad_perm:[2,3,0,1] row_mask:0xf bank_mask:0xf
    s_nop 1
    v_add_f32_dpp v40, v40, v40 row_half_mirror row_mask:0xf bank_mask:0xf
    v_add_f32_dpp v41, v41, v41 row_half_mirror row_mask:0xf bank_mask:0xf
    s_nop 1
    v_add_f32_dpp v40, v40, v40 row_mirror row_mask:0xf bank_mask:0xf
    v_add_f32_dpp v41, v41, v41 row_mirror row_mask:0xf bank_mask:0xf
    v_mov_b32 v42, v40
    v_mov_b32 v43, v41
    s_nop 1
    v_permlane16_swap_b32 v40, v42
    v_permlane16_swap_b32 v41, v43
    v_add_f32 v40, v40, v42
    v_add_f32 v41, v41, v43
    v_rcp_f32 v40, v40
    v_rcp_f32 v41, v41
    v_lshrrev_b32 v42, 5, v0
    v_lshlrev_b32 v42, 2, v42
    v_add_u32 v42, 0x20000, v42
    ds_write_b32 v42, v40 offset:4608
    ds_write_b32 v42, v41 offset:4616
Lw_nl2:
    s_waitcnt lgkmcnt(0)
    s_barrier
    s_cmp_lg_u32 s3, 7
    s_cbranch_scc1 Lef_14
    s_lshl_b32 s88, s79, 7
    s_add_u32 s88, s88, 413696
    v_mov_b32 v92, s80
    v_lshlrev_b32 v93, 2, v0
    s_mov_b32 exec_hi, 0
    buffer_store_dword v92, v93, s[44:47], s88 offen sc1
    s_mov_b64 exec, -1
Lef_14:
    ds_read_b128 v[16:19], v15 offset:0
    ds_read_b128 v[20:23], v15 offset:64
    ds_read_b128 v[24:27], v15 offset:128
    ds_read_b128 v[28:31], v15 offset:192
    v_lshlrev_b32 v42, 2, v14
    v_add_u32 v42, 0x20000, v42
    ds_read_b32 v43, v42 offset:4608
    v_cmp_gt_u32 vcc, 4, v2
    s_waitcnt lgkmcnt(4)
    v_mfma_f32_16x16x32_bf16 v[32:35], v[96:99], v[16:19], 0
    s_waitcnt lgkmcnt(3)
    v_mfma_f32_16x16x32_bf16 v[36:39], v[100:103], v[20:23], 0
    s_waitcnt lgkmcnt(2)
    v_mfma_f32_16x16x32_bf16 v[32:35], v[104:107], v[24:27], v[32:35]
    s_waitcnt lgkmcnt(1)
    v_mfma_f32_16x16x32_bf16 v[36:39], v[108:111], v[28:31], v[36:39]
    s_lshl_b32 s86, s79, 13
    s_lshl_b32 s87, s3, 10
    s_add_u32 s86, s86, s87
    s_add_u32 s86, s86, 1019904
    s_waitcnt lgkmcnt(0)
    s_nop 2
    v_add_f32 v32, v32, v36
    v_add_f32 v33, v33, v37
    v_add_f32 v34, v34, v38
    v_add_f32 v35, v35, v39
    v_mul_f32 v32, v32, v43
    v_mul_f32 v33, v33, v43
    v_mul_f32 v34, v34, v43
    v_mul_f32 v35, v35, v43
    v_cvt_pk_bf16_f32 v32, v32, v33
    v_cvt_pk_bf16_f32 v33, v34, v35
    s_mov_b64 exec, vcc
    ds_write_b64 v10, v[32:33]
    s_mov_b64 exec, -1
    s_waitcnt lgkmcnt(0)

    s_barrier
    ds_read_b128 v[16:19], v11 offset:0
    ds_read_b128 v[20:23], v11 offset:64
    ds_read_b128 v[24:27], v11 offset:128
    ds_read_b128 v[28:31], v11 offset:192
    v_cmp_eq_u32 vcc, 1, v3
    v_cmp_eq_u32 s[92:93], 2, v3
    v_cmp_eq_u32 s[94:95], 3, v3

    s_waitcnt lgkmcnt(3)
    v_mfma_f32_16x16x32_bf16 v[32:35], v[16:19], v[112:115], 0
    v_mfma_f32_16x16x32_bf16 v[36:39], v[16:19], v[116:119], 0
    v_mfma_f32_16x16x32_bf16 v[40:43], v[16:19], v[120:123], 0
    v_mfma_f32_16x16x32_bf16 v[44:47], v[16:19], v[124:127], 0
    s_waitcnt lgkmcnt(2)
    v_mfma_f32_16x16x32_bf16 v[32:35], v[20:23], v[128:131], v[32:35]
    v_mfma_f32_16x16x32_bf16 v[36:39], v[20:23], v[132:135], v[36:39]
    v_mfma_f32_16x16x32_bf16 v[40:43], v[20:23], v[136:139], v[40:43]
    v_mfma_f32_16x16x32_bf16 v[44:47], v[20:23], v[140:143], v[44:47]
    s_waitcnt lgkmcnt(1)
    v_mfma_f32_16x16x32_bf16 v[32:35], v[24:27], v[144:147], v[32:35]
    v_mfma_f32_16x16x32_bf16 v[36:39], v[24:27], v[148:151], v[36:39]
    v_mfma_f32_16x16x32_bf16 v[40:43], v[24:27], v[152:155], v[40:43]
    v_mfma_f32_16x16x32_bf16 v[44:47], v[24:27], v[156:159], v[44:47]
    s_waitcnt lgkmcnt(0)
    v_mfma_f32_16x16x32_bf16 v[32:35], v[28:31], v[160:163], v[32:35]
    v_mfma_f32_16x16x32_bf16 v[36:39], v[28:31], v[164:167], v[36:39]
    v_mfma_f32_16x16x32_bf16 v[40:43], v[28:31], v[168:171], v[40:43]
    v_mfma_f32_16x16x32_bf16 v[44:47], v[28:31], v[172:175], v[44:47]
    s_nop 5
    v_cndmask_b32 v32, v32, v36, vcc
    v_cndmask_b32 v33, v33, v37, vcc
    v_cndmask_b32 v34, v34, v38, vcc
    v_cndmask_b32 v35, v35, v39, vcc
    v_cndmask_b32 v32, v32, v40, s[92:93]
    v_cndmask_b32 v33, v33, v41, s[92:93]
    v_cndmask_b32 v34, v34, v42, s[92:93]
    v_cndmask_b32 v35, v35, v43, s[92:93]
    v_cndmask_b32 v32, v32, v44, s[94:95]
    v_cndmask_b32 v33, v33, v45, s[94:95]
    v_cndmask_b32 v34, v34, v46, s[94:95]
    v_cndmask_b32 v35, v35, v47, s[94:95]
    v_perm_b32 v32, v32, v35, s98
    v_perm_b32 v33, v33, v35, s99
    v_perm_b32 v34, v34, v35, s100
    v_mov_b32 v35, s80
    buffer_store_dwordx4 v[32:35], v4, s[44:47], s86 offen sc1
    s_branch Lfin
Latt_role:
    s_waitcnt lgkmcnt(0)
    s_mov_b32 s48, s18
    s_mov_b32 s49, s19
    s_load_dwordx8 s[24:31], s[0:1], 32
    s_load_dwordx8 s[32:39], s[0:1], 64
    s_add_u32 s84, s42, 0
    s_addc_u32 s85, s43, 0
    s_load_dword s80, s[84:85], 0
    s_mov_b32 s96, 0x05040100
    s_mov_b32 s97, 0x07060302
    s_mov_b32 s98, 0x07060501
    s_mov_b32 s99, 0x07060502
    s_mov_b32 s100, 0x07060503
    s_mov_b32 s8, 0x04000c0c
    s_mov_b32 s9, 0x0706000c
    s_mov_b32 s82, 0xfffefffe

    s_mov_b32 s44, s84
    s_mov_b32 s45, s85
    s_mov_b32 s46, 7835648
    s_mov_b32 s47, 0x20000
    s_cmp_lg_u32 s3, 0
    s_cbranch_scc1 La_pfw
    s_waitcnt vmcnt(0)
La_pfw:
    s_waitcnt lgkmcnt(0)
    s_and_b32 s86, s80, 0x88888888
    s_and_b32 s80, s80, 0x77777777
    s_add_u32 s80, s80, 0x11111111
    s_xor_b32 s80, s80, s86
    s_mov_b32 s72, s34
    s_mov_b32 s73, s35
    s_mov_b32 s74, 1835008
    s_mov_b32 s75, 0x20000
    s_and_b32 s76, s3, 3
    s_lshr_b32 s77, s3, 2
    v_and_b32 v28, 7, v2
    v_lshlrev_b32 v28, 1, v28
    v_xor_b32 v28, v28, v3
    v_lshlrev_b32 v28, 4, v28
    v_lshl_add_u32 v28, v2, 10, v28
    s_lshl_b32 s86, s76, 15
    s_lshl_b32 s87, s77, 14
    s_add_u32 s87, s87, 131072

    v_xor_b32 v20, 0, v28
    v_add_u32 v16, s86, v20
    v_add_u32 v20, s87, v20
    v_xor_b32 v21, 64, v28
    v_add_u32 v17, s86, v21
    v_add_u32 v21, s87, v21
    v_xor_b32 v22, 128, v28
    v_add_u32 v18, s86, v22
    v_add_u32 v22, s87, v22
    v_xor_b32 v23, 192, v28
    v_add_u32 v19, s86, v23
    v_add_u32 v23, s87, v23
    v_lshrrev_b32 v5, 2, v2
    v_lshl_add_u32 v5, v3, 2, v5
    v_and_b32 v6, 7, v5
    v_lshlrev_b32 v6, 5, v6
    v_lshl_add_u32 v6, v5, 10, v6
    v_and_b32 v5, 3, v2
    v_lshl_add_u32 v6, v5, 3, v6
    s_lshl_b32 s86, s76, 8
    v_add_u32 v24, s86, v6
    v_xor_b32 v25, 32, v24
    v_xor_b32 v26, 64, v24
    v_xor_b32 v27, 96, v24
    v_xor_b32 v28, 128, v24
    v_xor_b32 v29, 160, v24
    v_xor_b32 v30, 192, v24
    v_xor_b32 v31, 224, v24
    s_lshr_b32 s4, s78, 5
    s_lshl_b32 s4, s4, 15
    s_lshl_b32 s87, s3, 12
    s_add_u32 s4, s4, s87
    s_add_u32 s4, s4, 266240
    s_add_u32 s5, s87, 131072
    s_and_b32 s88, s3, 1
    s_lshl_b32 s88, s88, 7
    v_xor_b32 v12, s88, v4
    v_xor_b32 v13, 32, v12
    v_xor_b32 v14, 64, v12
    v_xor_b32 v15, 96, v12
    v_add_u32 v56, s5, v12
    v_add_u32 v57, s5, v13
    v_add_u32 v58, s5, v14
    v_add_u32 v59, s5, v15
    s_lshl_b32 s86, s77, 8
    v_lshlrev_b32 v8, 4, v2
    v_add_u32 v8, s86, v8
    s_lshl_b32 s86, s76, 2
    v_add_u32 v9, s86, v8
    s_lshl_b32 s86, s3, 10
    v_add_u32 v10, s86, v4
    s_lshl_b32 s86, s3, 8
    v_lshlrev_b32 v11, 2, v0
    v_add_u32 v11, s86, v11
    v_lshlrev_b32 v7, 19, v3
    v_lshl_add_u32 v7, v2, 4, v7
    s_lshl_b32 s79, s77, 21
    s_lshl_b32 s86, s76, 15
    s_add_u32 s79, s79, s86
    s_lshl_b32 s86, s78, 8
    s_add_u32 s79, s79, s86
    s_add_u32 s79, s79, 3117056
    s_min_u32 s81, s78, 111
    s_mov_b32 s90, 0

    s_barrier
    ds_read_b64_tr_b16 v[192:193], v24 offset:0
    ds_read_b64_tr_b16 v[194:195], v24 offset:16384
    ds_read_b64_tr_b16 v[196:197], v25 offset:0
    ds_read_b64_tr_b16 v[198:199], v25 offset:16384
    ds_read_b64_tr_b16 v[200:201], v26 offset:0
    ds_read_b64_tr_b16 v[202:203], v26 offset:16384
    ds_read_b64_tr_b16 v[204:205], v27 offset:0
    ds_read_b64_tr_b16 v[206:207], v27 offset:16384
    ds_read_b64_tr_b16 v[208:209], v28 offset:0
    ds_read_b64_tr_b16 v[210:211], v28 offset:16384
    ds_read_b64_tr_b16 v[212:213], v29 offset:0
    ds_read_b64_tr_b16 v[214:215], v29 offset:16384
    ds_read_b64_tr_b16 v[216:217], v30 offset:0
    ds_read_b64_tr_b16 v[218:219], v30 offset:16384
    ds_read_b64_tr_b16 v[220:221], v31 offset:0
    ds_read_b64_tr_b16 v[222:223], v31 offset:16384
    s_cmp_lg_u32 s76, 0
    s_cbranch_scc1 La_o0
    ds_read_b128 v[64:67], v16 offset:0
    ds_read_b128 v[68:71], v16 offset:16384
    ds_read_b128 v[72:75], v17 offset:0
    ds_read_b128 v[76:79], v17 offset:16384
    ds_read_b128 v[80:83], v18 offset:0
    ds_read_b128 v[84:87], v18 offset:16384
    ds_read_b128 v[88:91], v19 offset:0
    ds_read_b128 v[92:95], v19 offset:16384
    ds_read_b128 v[96:99], v16 offset:256
    ds_read_b128 v[100:103], v16 offset:16640
    ds_read_b128 v[104:107], v17 offset:256
    ds_read_b128 v[108:111], v17 offset:16640
    ds_read_b128 v[112:115], v18 offset:256
    ds_read_b128 v[116:119], v18 offset:16640
    ds_read_b128 v[120:123], v19 offset:256
    ds_read_b128 v[124:127], v19 offset:16640
    ds_read_b128 v[128:131], v16 offset:512
    ds_read_b128 v[132:135], v16 offset:16896
    ds_read_b128 v[136:139], v17 offset:512
    ds_read_b128 v[140:143], v17 offset:16896
    ds_read_b128 v[144:147], v18 offset:512
    ds_read_b128 v[148:151], v18 offset:16896
    ds_read_b128 v[152:155], v19 offset:512
    ds_read_b128 v[156:159], v19 offset:16896
    ds_read_b128 v[160:163], v16 offset:768
    ds_read_b128 v[164:167], v16 offset:17152
    ds_read_b128 v[168:171], v17 offset:768
    ds_read_b128 v[172:175], v17 offset:17152
    ds_read_b128 v[176:179], v18 offset:768
    ds_read_b128 v[180:183], v18 offset:17152
    ds_read_b128 v[184:187], v19 offset:768
    ds_read_b128 v[188:191], v19 offset:17152
La_o0:
    s_barrier
    ds_read_b64_tr_b16 v[224:225], v24 offset:32768
    ds_read_b64_tr_b16 v[226:227], v24 offset:49152
    ds_read_b64_tr_b16 v[228:229], v25 offset:32768
    ds_read_b64_tr_b16 v[230:231], v25 offset:49152
    ds_read_b64_tr_b16 v[232:233], v26 offset:32768
    ds_read_b64_tr_b16 v[234:235], v26 offset:49152
    ds_read_b64_tr_b16 v[236:237], v27 offset:32768
    ds_read_b64_tr_b16 v[238:239], v27 offset:49152
    ds_read_b64_tr_b16 v[240:241], v28 offset:32768
    ds_read_b64_tr_b16 v[242:243], v28 offset:49152
    ds_read_b64_tr_b16 v[244:245], v29 offset:32768
    ds_read_b64_tr_b16 v[246:247], v29 offset:49152
    ds_read_b64_tr_b16 v[248:249], v30 offset:32768
    ds_read_b64_tr_b16 v[250:251], v30 offset:49152
    ds_read_b64_tr_b16 v[252:253], v31 offset:32768
    ds_read_b64_tr_b16 v[254:255], v31 offset:49152
    s_cmp_lg_u32 s76, 1
    s_cbranch_scc1 La_o1
    ds_read_b128 v[64:67], v16 offset:0
    ds_read_b128 v[68:71], v16 offset:16384
    ds_read_b128 v[72:75], v17 offset:0
    ds_read_b128 v[76:79], v17 offset:16384
    ds_read_b128 v[80:83], v18 offset:0
    ds_read_b128 v[84:87], v18 offset:16384
    ds_read_b128 v[88:91], v19 offset:0
    ds_read_b128 v[92:95], v19 offset:16384
    ds_read_b128 v[96:99], v16 offset:256
    ds_read_b128 v[100:103], v16 offset:16640
    ds_read_b128 v[104:107], v17 offset:256
    ds_read_b128 v[108:111], v17 offset:16640
    ds_read_b128 v[112:115], v18 offset:256
    ds_read_b128 v[116:119], v18 offset:16640
    ds_read_b128 v[120:123], v19 offset:256
    ds_read_b128 v[124:127], v19 offset:16640
    ds_read_b128 v[128:131], v16 offset:512
    ds_read_b128 v[132:135], v16 offset:16896
    ds_read_b128 v[136:139], v17 offset:512
    ds_read_b128 v[140:143], v17 offset:16896
    ds_read_b128 v[144:147], v18 offset:512
    ds_read_b128 v[148:151], v18 offset:16896
    ds_read_b128 v[152:155], v19 offset:512
    ds_read_b128 v[156:159], v19 offset:16896
    ds_read_b128 v[160:163], v16 offset:768
    ds_read_b128 v[164:167], v16 offset:17152
    ds_read_b128 v[168:171], v17 offset:768
    ds_read_b128 v[172:175], v17 offset:17152
    ds_read_b128 v[176:179], v18 offset:768
    ds_read_b128 v[180:183], v18 offset:17152
    ds_read_b128 v[184:187], v19 offset:768
    ds_read_b128 v[188:191], v19 offset:17152
La_o1:
    s_branch La_noload
La_load:
    s_load_dwordx8 s[24:31], s[0:1], 32
    s_load_dwordx8 s[32:39], s[0:1], 64
    s_add_u32 s84, s42, 0
    s_addc_u32 s85, s43, 0
    s_load_dword s80, s[84:85], 0
    s_mov_b32 s96, 0x05040100
    s_mov_b32 s97, 0x07060302
    s_mov_b32 s98, 0x07060501
    s_mov_b32 s99, 0x07060502
    s_mov_b32 s100, 0x07060503
    s_mov_b32 s8, 0x04000c0c
    s_mov_b32 s9, 0x0706000c
    s_mov_b32 s82, 0xfffefffe

    s_mov_b32 s44, s84
    s_mov_b32 s45, s85
    s_mov_b32 s46, 7835648
    s_mov_b32 s47, 0x20000
    s_add_u32 m0, s7, 40960
    s_add_u32 s88, s6, 1310720
    buffer_load_dwordx4 v60, s[48:51], s88 offen nt lds
    s_waitcnt vmcnt(10)
    s_add_u32 m0, s7, 45056
    s_add_u32 s88, s6, 1314816
    buffer_load_dwordx4 v61, s[48:51], s88 offen nt lds
    s_waitcnt vmcnt(10)
    s_add_u32 m0, s7, 49152
    s_add_u32 s88, s6, 1572864
    buffer_load_dwordx4 v60, s[48:51], s88 offen nt lds
    s_waitcnt vmcnt(10)
    s_waitcnt lgkmcnt(0)
    s_and_b32 s86, s80, 0x88888888
    s_and_b32 s80, s80, 0x77777777
    s_add_u32 s80, s80, 0x11111111
    s_xor_b32 s80, s80, s86
    s_mov_b32 s72, s34
    s_mov_b32 s73, s35
    s_mov_b32 s74, 1835008
    s_mov_b32 s75, 0x20000
    s_and_b32 s76, s3, 3
    s_lshr_b32 s77, s3, 2
    v_and_b32 v28, 7, v2
    v_lshlrev_b32 v28, 1, v28
    v_xor_b32 v28, v28, v3
    v_lshlrev_b32 v28, 4, v28
    v_lshl_add_u32 v28, v2, 10, v28
    s_lshl_b32 s86, s76, 15
    s_lshl_b32 s87, s77, 14
    s_add_u32 s87, s87, 131072

    v_xor_b32 v20, 0, v28
    v_add_u32 v16, s86, v20
    v_add_u32 v20, s87, v20
    v_xor_b32 v21, 64, v28
    v_add_u32 v17, s86, v21
    v_add_u32 v21, s87, v21
    v_xor_b32 v22, 128, v28
    v_add_u32 v18, s86, v22
    v_add_u32 v22, s87, v22
    v_xor_b32 v23, 192, v28
    v_add_u32 v19, s86, v23
    v_add_u32 v23, s87, v23
    v_lshrrev_b32 v5, 2, v2
    v_lshl_add_u32 v5, v3, 2, v5
    v_and_b32 v6, 7, v5
    v_lshlrev_b32 v6, 5, v6
    v_lshl_add_u32 v6, v5, 10, v6
    v_and_b32 v5, 3, v2
    v_lshl_add_u32 v6, v5, 3, v6
    s_lshl_b32 s86, s76, 8
    v_add_u32 v24, s86, v6
    v_xor_b32 v25, 32, v24
    v_xor_b32 v26, 64, v24
    v_xor_b32 v27, 96, v24
    v_xor_b32 v28, 128, v24
    v_xor_b32 v29, 160, v24
    v_xor_b32 v30, 192, v24
    v_xor_b32 v31, 224, v24
    s_lshr_b32 s4, s78, 5
    s_lshl_b32 s4, s4, 15
    s_lshl_b32 s87, s3, 12
    s_add_u32 s4, s4, s87
    s_add_u32 s4, s4, 266240
    s_add_u32 s5, s87, 131072
    s_and_b32 s88, s3, 1
    s_lshl_b32 s88, s88, 7
    v_xor_b32 v12, s88, v4
    v_xor_b32 v13, 32, v12
    v_xor_b32 v14, 64, v12
    v_xor_b32 v15, 96, v12
    v_add_u32 v56, s5, v12
    v_add_u32 v57, s5, v13
    v_add_u32 v58, s5, v14
    v_add_u32 v59, s5, v15
    s_lshl_b32 s86, s77, 8
    v_lshlrev_b32 v8, 4, v2
    v_add_u32 v8, s86, v8
    s_lshl_b32 s86, s76, 2
    v_add_u32 v9, s86, v8
    s_lshl_b32 s86, s3, 10
    v_add_u32 v10, s86, v4
    s_lshl_b32 s86, s3, 8
    v_lshlrev_b32 v11, 2, v0
    v_add_u32 v11, s86, v11
    v_lshlrev_b32 v7, 19, v3
    v_lshl_add_u32 v7, v2, 4, v7
    s_lshl_b32 s79, s77, 21
    s_lshl_b32 s86, s76, 15
    s_add_u32 s79, s79, s86
    s_lshl_b32 s86, s78, 8
    s_add_u32 s79, s79, s86
    s_add_u32 s79, s79, 3117056
    s_min_u32 s81, s78, 111
    s_mov_b32 s90, 0

    s_add_u32 m0, s7, 53248
    s_add_u32 s88, s6, 1576960
    buffer_load_dwordx4 v61, s[48:51], s88 offen nt lds
    s_waitcnt vmcnt(10)
    s_add_u32 m0, s7, 57344
    s_add_u32 s88, s6, 1835008
    buffer_load_dwordx4 v60, s[48:51], s88 offen nt lds
    s_waitcnt vmcnt(10)
    s_add_u32 m0, s7, 61440
    s_add_u32 s88, s6, 1839104
    buffer_load_dwordx4 v61, s[48:51], s88 offen nt lds
    s_waitcnt vmcnt(10)
    s_add_u32 m0, s7, 65536
    s_add_u32 s88, s6, 2097152
    buffer_load_dwordx4 v60, s[48:51], s88 offen nt lds
    s_waitcnt vmcnt(10)
    s_add_u32 m0, s7, 69632
    s_add_u32 s88, s6, 2101248
    buffer_load_dwordx4 v61, s[48:51], s88 offen nt lds
    s_waitcnt vmcnt(10)
    s_add_u32 m0, s7, 73728
    s_add_u32 s88, s6, 2359296
    buffer_load_dwordx4 v60, s[48:51], s88 offen nt lds
    s_waitcnt vmcnt(10)
    s_barrier
    ds_read_b64_tr_b16 v[192:193], v24 offset:0
    ds_read_b64_tr_b16 v[194:195], v24 offset:16384
    s_cmp_lg_u32 s76, 0
    s_cbranch_scc1 La_q_15
    ds_read_b128 v[64:67], v16 offset:0
    ds_read_b128 v[68:71], v16 offset:16384
    ds_read_b128 v[72:75], v17 offset:0
    ds_read_b128 v[76:79], v17 offset:16384
La_q_15:
    s_add_u32 m0, s7, 77824
    s_add_u32 s88, s6, 2363392
    buffer_load_dwordx4 v61, s[48:51], s88 offen nt lds
    s_waitcnt vmcnt(10)
    ds_read_b64_tr_b16 v[196:197], v25 offset:0
    ds_read_b64_tr_b16 v[198:199], v25 offset:16384
    s_cmp_lg_u32 s76, 0
    s_cbranch_scc1 La_q_16
    ds_read_b128 v[80:83], v18 offset:0
    ds_read_b128 v[84:87], v18 offset:16384
    ds_read_b128 v[88:91], v19 offset:0
    ds_read_b128 v[92:95], v19 offset:16384
La_q_16:
    s_add_u32 m0, s7, 81920
    s_add_u32 s88, s6, 2621440
    buffer_load_dwordx4 v60, s[48:51], s88 offen nt lds
    s_waitcnt vmcnt(10)
    ds_read_b64_tr_b16 v[200:201], v26 offset:0
    ds_read_b64_tr_b16 v[202:203], v26 offset:16384
    s_cmp_lg_u32 s76, 0
    s_cbranch_scc1 La_q_17
    ds_read_b128 v[96:99], v16 offset:256
    ds_read_b128 v[100:103], v16 offset:16640
    ds_read_b128 v[104:107], v17 offset:256
    ds_read_b128 v[108:111], v17 offset:16640
La_q_17:
    s_add_u32 m0, s7, 86016
    s_add_u32 s88, s6, 2625536
    buffer_load_dwordx4 v61, s[48:51], s88 offen nt lds
    s_waitcnt vmcnt(10)
    ds_read_b64_tr_b16 v[204:205], v27 offset:0
    ds_read_b64_tr_b16 v[206:207], v27 offset:16384
    s_cmp_lg_u32 s76, 0
    s_cbranch_scc1 La_q_18
    ds_read_b128 v[112:115], v18 offset:256
    ds_read_b128 v[116:119], v18 offset:16640
    ds_read_b128 v[120:123], v19 offset:256
    ds_read_b128 v[124:127], v19 offset:16640
La_q_18:
    s_add_u32 m0, s7, 90112
    s_add_u32 s88, s6, 2883584
    buffer_load_dwordx4 v60, s[48:51], s88 offen nt lds
    s_waitcnt vmcnt(10)
    ds_read_b64_tr_b16 v[208:209], v28 offset:0
    ds_read_b64_tr_b16 v[210:211], v28 offset:16384
    s_cmp_lg_u32 s76, 0
    s_cbranch_scc1 La_q_19
    ds_read_b128 v[128:131], v16 offset:512
    ds_read_b128 v[132:135], v16 offset:16896
    ds_read_b128 v[136:139], v17 offset:512
    ds_read_b128 v[140:143], v17 offset:16896
La_q_19:
    s_add_u32 m0, s7, 94208
    s_add_u32 s88, s6, 2887680
    buffer_load_dwordx4 v61, s[48:51], s88 offen nt lds
    s_waitcnt vmcnt(10)
    ds_read_b64_tr_b16 v[212:213], v29 offset:0
    ds_read_b64_tr_b16 v[214:215], v29 offset:16384
    s_cmp_lg_u32 s76, 0
    s_cbranch_scc1 La_q_20
    ds_read_b128 v[144:147], v18 offset:512
    ds_read_b128 v[148:151], v18 offset:16896
    ds_read_b128 v[152:155], v19 offset:512
    ds_read_b128 v[156:159], v19 offset:16896
La_q_20:
    s_add_u32 m0, s7, 98304
    s_add_u32 s88, s6, 3145728
    buffer_load_dwordx4 v60, s[48:51], s88 offen nt lds
    s_waitcnt vmcnt(10)
    ds_read_b64_tr_b16 v[216:217], v30 offset:0
    ds_read_b64_tr_b16 v[218:219], v30 offset:16384
    s_cmp_lg_u32 s76, 0
    s_cbranch_scc1 La_q_21
    ds_read_b128 v[160:163], v16 offset:768
    ds_read_b128 v[164:167], v16 offset:17152
    ds_read_b128 v[168:171], v17 offset:768
    ds_read_b128 v[172:175], v17 offset:17152
La_q_21:
    s_add_u32 m0, s7, 102400
    s_add_u32 s88, s6, 3149824
    buffer_load_dwordx4 v61, s[48:51], s88 offen nt lds
    s_waitcnt vmcnt(10)
    ds_read_b64_tr_b16 v[220:221], v31 offset:0
    ds_read_b64_tr_b16 v[222:223], v31 offset:16384
    s_cmp_lg_u32 s76, 0
    s_cbranch_scc1 La_q_22
    ds_read_b128 v[176:179], v18 offset:768
    ds_read_b128 v[180:183], v18 offset:17152
    ds_read_b128 v[184:187], v19 offset:768
    ds_read_b128 v[188:191], v19 offset:17152
La_q_22:
    s_add_u32 m0, s7, 106496
    s_add_u32 s88, s6, 3407872
    buffer_load_dwordx4 v60, s[48:51], s88 offen nt lds
    s_waitcnt vmcnt(10)
    s_barrier
    ds_read_b64_tr_b16 v[224:225], v24 offset:32768
    ds_read_b64_tr_b16 v[226:227], v24 offset:49152
    s_cmp_lg_u32 s76, 1
    s_cbranch_scc1 La_q_23
    ds_read_b128 v[64:67], v16 offset:0
    ds_read_b128 v[68:71], v16 offset:16384
    ds_read_b128 v[72:75], v17 offset:0
    ds_read_b128 v[76:79], v17 offset:16384
La_q_23:
    s_add_u32 m0, s7, 110592
    s_add_u32 s88, s6, 3411968
    buffer_load_dwordx4 v61, s[48:51], s88 offen nt lds
    s_waitcnt vmcnt(10)
    ds_read_b64_tr_b16 v[228:229], v25 offset:32768
    ds_read_b64_tr_b16 v[230:231], v25 offset:49152
    s_cmp_lg_u32 s76, 1
    s_cbranch_scc1 La_q_24
    ds_read_b128 v[80:83], v18 offset:0
    ds_read_b128 v[84:87], v18 offset:16384
    ds_read_b128 v[88:91], v19 offset:0
    ds_read_b128 v[92:95], v19 offset:16384
La_q_24:
    s_add_u32 m0, s7, 114688
    s_add_u32 s88, s6, 3670016
    buffer_load_dwordx4 v60, s[48:51], s88 offen nt lds
    s_waitcnt vmcnt(10)
    ds_read_b64_tr_b16 v[232:233], v26 offset:32768
    ds_read_b64_tr_b16 v[234:235], v26 offset:49152
    s_cmp_lg_u32 s76, 1
    s_cbranch_scc1 La_q_25
    ds_read_b128 v[96:99], v16 offset:256
    ds_read_b128 v[100:103], v16 offset:16640
    ds_read_b128 v[104:107], v17 offset:256
    ds_read_b128 v[108:111], v17 offset:16640
La_q_25:
    s_add_u32 m0, s7, 118784
    s_add_u32 s88, s6, 3674112
    buffer_load_dwordx4 v61, s[48:51], s88 offen nt lds
    s_waitcnt vmcnt(10)
    ds_read_b64_tr_b16 v[236:237], v27 offset:32768
    ds_read_b64_tr_b16 v[238:239], v27 offset:49152
    s_cmp_lg_u32 s76, 1
    s_cbranch_scc1 La_q_26
    ds_read_b128 v[112:115], v18 offset:256
    ds_read_b128 v[116:119], v18 offset:16640
    ds_read_b128 v[120:123], v19 offset:256
    ds_read_b128 v[124:127], v19 offset:16640
La_q_26:
    s_add_u32 m0, s7, 122880
    s_add_u32 s88, s6, 3932160
    buffer_load_dwordx4 v60, s[48:51], s88 offen nt lds
    s_waitcnt vmcnt(10)
    ds_read_b64_tr_b16 v[240:241], v28 offset:32768
    ds_read_b64_tr_b16 v[242:243], v28 offset:49152
    s_cmp_lg_u32 s76, 1
    s_cbranch_scc1 La_q_27
    ds_read_b128 v[128:131], v16 offset:512
    ds_read_b128 v[132:135], v16 offset:16896
    ds_read_b128 v[136:139], v17 offset:512
    ds_read_b128 v[140:143], v17 offset:16896
La_q_27:
    s_add_u32 m0, s7, 126976
    s_add_u32 s88, s6, 3936256
    buffer_load_dwordx4 v61, s[48:51], s88 offen nt lds
    ds_read_b64_tr_b16 v[244:245], v29 offset:32768
    ds_read_b64_tr_b16 v[246:247], v29 offset:49152
    ds_read_b64_tr_b16 v[248:249], v30 offset:32768
    ds_read_b64_tr_b16 v[250:251], v30 offset:49152
    ds_read_b64_tr_b16 v[252:253], v31 offset:32768
    ds_read_b64_tr_b16 v[254:255], v31 offset:49152
    s_cmp_lg_u32 s76, 1
    s_cbranch_scc1 La_q_28
    ds_read_b128 v[144:147], v18 offset:512
    ds_read_b128 v[148:151], v18 offset:16896
    ds_read_b128 v[152:155], v19 offset:512
    ds_read_b128 v[156:159], v19 offset:16896
    ds_read_b128 v[160:163], v16 offset:768
    ds_read_b128 v[164:167], v16 offset:17152
    ds_read_b128 v[168:171], v17 offset:768
    ds_read_b128 v[172:175], v17 offset:17152
    ds_read_b128 v[176:179], v18 offset:768
    ds_read_b128 v[180:183], v18 offset:17152
    ds_read_b128 v[184:187], v19 offset:768
    ds_read_b128 v[188:191], v19 offset:17152
La_q_28:
    s_waitcnt vmcnt(8)
La_noload:
    s_waitcnt lgkmcnt(0)
    s_barrier
    s_cmp_lg_u32 s76, 2
    s_cbranch_scc1 La_late
    ds_read_b128 v[64:67], v16 offset:0
    ds_read_b128 v[68:71], v16 offset:16384
    ds_read_b128 v[72:75], v17 offset:0
    ds_read_b128 v[76:79], v17 offset:16384
    ds_read_b128 v[80:83], v18 offset:0
    ds_read_b128 v[84:87], v18 offset:16384
    ds_read_b128 v[88:91], v19 offset:0
    ds_read_b128 v[92:95], v19 offset:16384
    ds_read_b128 v[96:99], v16 offset:256
    ds_read_b128 v[100:103], v16 offset:16640
    ds_read_b128 v[104:107], v17 offset:256
    ds_read_b128 v[108:111], v17 offset:16640
    ds_read_b128 v[112:115], v18 offset:256
    ds_read_b128 v[116:119], v18 offset:16640
    ds_read_b128 v[120:123], v19 offset:256
    ds_read_b128 v[124:127], v19 offset:16640
    ds_read_b128 v[128:131], v16 offset:512
    ds_read_b128 v[132:135], v16 offset:16896
    ds_read_b128 v[136:139], v17 offset:512
    ds_read_b128 v[140:143], v17 offset:16896
    ds_read_b128 v[144:147], v18 offset:512
    ds_read_b128 v[148:151], v18 offset:16896
    ds_read_b128 v[152:155], v19 offset:512
    ds_read_b128 v[156:159], v19 offset:16896
    ds_read_b128 v[160:163], v16 offset:768
    ds_read_b128 v[164:167], v16 offset:17152
    ds_read_b128 v[168:171], v17 offset:768
    ds_read_b128 v[172:175], v17 offset:17152
    ds_read_b128 v[176:179], v18 offset:768
    ds_read_b128 v[180:183], v18 offset:17152
    ds_read_b128 v[184:187], v19 offset:768
    ds_read_b128 v[188:191], v19 offset:17152
La_late:
    v_add_u32 v24, 0x10000, v24
    v_add_u32 v25, 0x10000, v25
    v_add_u32 v26, 0x10000, v26
    v_add_u32 v27, 0x10000, v27
    v_add_u32 v28, 0x10000, v28
    v_add_u32 v29, 0x10000, v29
    v_add_u32 v30, 0x10000, v30
    v_add_u32 v31, 0x10000, v31
    v_mov_b32 v32, -1
    v_mov_b32 v33, -1
    v_mov_b32 v34, -1
    v_mov_b32 v35, -1
    s_lshl_b32 s86, s3, 2
    v_mov_b32 v62, s86
    s_lshl_b32 s86, s77, 4
    v_mov_b32 v63, s86
    ds_write_b128 v10, v[32:35] offset:1024
    ds_write_b32 v9, v32 offset:0
    ds_write_b32 v11, v32 offset:9216
    ds_write_b32 v62, v32 offset:528
    v_and_b32 v5, 3, v0
    v_lshlrev_b32 v5, 2, v5
    v_mov_b32 v37, s80
    v_lshrrev_b32 v36, v5, v37
    v_bfe_u32 v52, v36, 0, 1
    v_xor_b32 v37, 1, v52
    v_lshl_or_b32 v52, v37, 16, v52
    v_bfe_u32 v53, v36, 1, 1
    v_xor_b32 v37, 1, v53
    v_lshl_or_b32 v53, v37, 16, v53
    v_bfe_u32 v54, v36, 2, 1
    v_xor_b32 v37, 1, v54
    v_lshl_or_b32 v54, v37, 16, v54
    v_bfe_u32 v55, v36, 3, 1
    v_xor_b32 v37, 1, v55
    v_lshl_or_b32 v55, v37, 16, v55
    v_mov_b32 v6, 0
    s_cmp_lg_u32 s77, 0
    s_cbranch_scc1 La_yg
    ds_write_b32 v62, v32 offset:512
    s_branch La_b2
La_yg:
    s_waitcnt vmcnt(0)
La_b2:
    s_waitcnt lgkmcnt(0)
    s_barrier
    s_add_u32 m0, s5, 0
    s_add_u32 s88, s4, 0
    buffer_load_dwordx4 v12, s[44:47], s88 offen sc1 lds
    s_add_u32 m0, s5, 1024
    s_add_u32 s88, s4, 1024
    buffer_load_dwordx4 v13, s[44:47], s88 offen sc1 lds
    s_add_u32 m0, s5, 2048
    s_add_u32 s88, s4, 2048
    buffer_load_dwordx4 v14, s[44:47], s88 offen sc1 lds
    s_add_u32 m0, s5, 3072
    s_add_u32 s88, s4, 3072
    buffer_load_dwordx4 v15, s[44:47], s88 offen sc1 lds
    s_cmp_lg_u32 s76, 3
    s_cbranch_scc1 La_late2
    ds_read_b128 v[64:67], v16 offset:0
    ds_read_b128 v[68:71], v16 offset:16384
    ds_read_b128 v[72:75], v17 offset:0
    ds_read_b128 v[76:79], v17 offset:16384
    ds_read_b128 v[80:83], v18 offset:0
    ds_read_b128 v[84:87], v18 offset:16384
    ds_read_b128 v[88:91], v19 offset:0
    ds_read_b128 v[92:95], v19 offset:16384
    ds_read_b128 v[96:99], v16 offset:256
    ds_read_b128 v[100:103], v16 offset:16640
    ds_read_b128 v[104:107], v17 offset:256
    ds_read_b128 v[108:111], v17 offset:16640
    ds_read_b128 v[112:115], v18 offset:256
    ds_read_b128 v[116:119], v18 offset:16640
    ds_read_b128 v[120:123], v19 offset:256
    ds_read_b128 v[124:127], v19 offset:16640
    ds_read_b128 v[128:131], v16 offset:512
    ds_read_b128 v[132:135], v16 offset:16896
    ds_read_b128 v[136:139], v17 offset:512
    ds_read_b128 v[140:143], v17 offset:16896
    ds_read_b128 v[144:147], v18 offset:512
    ds_read_b128 v[148:151], v18 offset:16896
    ds_read_b128 v[152:155], v19 offset:512
    ds_read_b128 v[156:159], v19 offset:16896
    ds_read_b128 v[160:163], v16 offset:768
    ds_read_b128 v[164:167], v16 offset:17152
    ds_read_b128 v[168:171], v17 offset:768
    ds_read_b128 v[172:175], v17 offset:17152
    ds_read_b128 v[176:179], v18 offset:768
    ds_read_b128 v[180:183], v18 offset:17152
    ds_read_b128 v[184:187], v19 offset:768
    ds_read_b128 v[188:191], v19 offset:17152
La_late2:
    v_mov_b32 v16, v52
    v_mov_b32 v17, v53
    v_mov_b32 v18, v54
    v_mov_b32 v19, v55
    s_cmp_eq_u32 s90, -1
    s_cbranch_scc1 La_gs0
    s_branch La_chk0
    s_cbranch_scc1 La_chk0
La_re:
    s_add_u32 m0, s5, 0
    s_add_u32 s88, s4, 0
    buffer_load_dwordx4 v12, s[44:47], s88 offen sc1 lds
    s_add_u32 m0, s5, 1024
    s_add_u32 s88, s4, 1024
    buffer_load_dwordx4 v13, s[44:47], s88 offen sc1 lds
    s_add_u32 m0, s5, 2048
    s_add_u32 s88, s4, 2048
    buffer_load_dwordx4 v14, s[44:47], s88 offen sc1 lds
    s_add_u32 m0, s5, 3072
    s_add_u32 s88, s4, 3072
    buffer_load_dwordx4 v15, s[44:47], s88 offen sc1 lds
La_chk0:
    s_waitcnt vmcnt(0)
    ds_read_b128 v[32:35], v56 offset:0
    ds_read_b128 v[36:39], v57 offset:1024
    ds_read_b128 v[40:43], v58 offset:2048
    ds_read_b128 v[44:47], v59 offset:3072
    s_waitcnt lgkmcnt(0)
    v_xor_b32 v5, v32, v52
    v_bitop3_b32 v5, v5, v33, v53 bitop3:0xf6
    v_bitop3_b32 v5, v5, v34, v54 bitop3:0xf6
    v_bitop3_b32 v5, v5, v35, v55 bitop3:0xf6
    v_bitop3_b32 v5, v5, v36, v52 bitop3:0xf6
    v_bitop3_b32 v5, v5, v37, v53 bitop3:0xf6
    v_bitop3_b32 v5, v5, v38, v54 bitop3:0xf6
    v_bitop3_b32 v5, v5, v39, v55 bitop3:0xf6
    v_bitop3_b32 v5, v5, v40, v52 bitop3:0xf6
    v_bitop3_b32 v5, v5, v41, v53 bitop3:0xf6
    v_bitop3_b32 v5, v5, v42, v54 bitop3:0xf6
    v_bitop3_b32 v5, v5, v43, v55 bitop3:0xf6
    v_bitop3_b32 v5, v5, v44, v52 bitop3:0xf6
    v_bitop3_b32 v5, v5, v45, v53 bitop3:0xf6
    v_bitop3_b32 v5, v5, v46, v54 bitop3:0xf6
    v_bitop3_b32 v5, v5, v47, v55 bitop3:0xf6
    v_and_b32 v5, 0x10001, v5
    v_cmp_ne_u32 vcc, 0, v5
    s_cbranch_vccz La_ok
    s_add_u32 s90, s90, 1
    s_cmp_lt_u32 s90, 40000
    s_cbranch_scc1 La_re
La_ok:
    ds_write_b32 v62, v6 offset:528
La_gs0:
    s_mov_b32 s90, 0
La_gs:
    ds_read_b128 v[32:35], v63 offset:528
    s_add_u32 s90, s90, 1
    s_cmp_lt_u32 s90, 2560000
    s_cselect_b64 s[92:93], -1, 0
    s_waitcnt lgkmcnt(0)
    v_or3_b32 v32, v32, v33, v34
    v_or_b32 v32, v32, v35
    v_cmp_ne_u32 vcc, 0, v32
    s_nop 0
    s_and_b64 vcc, vcc, s[92:93]
    s_cbranch_vccnz La_gs
    ds_read_b128 v[32:35], v20 offset:0
    ds_read_b128 v[36:39], v21 offset:0
    ds_read_b128 v[40:43], v22 offset:0
    ds_read_b128 v[44:47], v23 offset:0
    ds_read_b128 v[48:51], v20 offset:256
    ds_read_b128 v[52:55], v21 offset:256
    s_waitcnt lgkmcnt(5)
    v_mfma_f32_16x16x32_bf16 v[56:59], v[64:67], v[32:35], 0
    v_mfma_f32_16x16x32_bf16 v[60:63], v[68:71], v[32:35], 0
    ds_read_b128 v[32:35], v22 offset:256
    s_waitcnt lgkmcnt(5)
    v_mfma_f32_16x16x32_bf16 v[56:59], v[72:75], v[36:39], v[56:59]
    v_mfma_f32_16x16x32_bf16 v[60:63], v[76:79], v[36:39], v[60:63]
    ds_read_b128 v[36:39], v23 offset:256
    s_cmp_lg_u32 s77, 0
    s_cbranch_scc1 La_nw2
    s_and_b32 s86, s3, 1
    s_lshl_b32 s86, s86, 7
    v_xor_b32 v12, s86, v4
    s_lshl_b32 s87, s81, 14
    s_lshl_b32 s86, s3, 12
    s_add_u32 s87, s87, s86
    s_add_u32 m0, s86, 32768
    s_add_u32 s88, s87, 0
    v_xor_b32 v13, 0, v12
    buffer_load_dwordx4 v13, s[72:75], s88 offen nt lds
    s_add_u32 m0, s86, 33792
    s_add_u32 s88, s87, 1024
    v_xor_b32 v13, 32, v12
    buffer_load_dwordx4 v13, s[72:75], s88 offen nt lds
    s_add_u32 m0, s86, 34816
    s_add_u32 s88, s87, 2048
    v_xor_b32 v13, 64, v12
    buffer_load_dwordx4 v13, s[72:75], s88 offen nt lds
    s_add_u32 m0, s86, 35840
    s_add_u32 s88, s87, 3072
    v_xor_b32 v13, 96, v12
    buffer_load_dwordx4 v13, s[72:75], s88 offen nt lds
    s_lshr_b32 s7, s81, 3
    s_lshl_b32 s7, s7, 13
    s_and_b32 s87, s81, 7
    s_lshl_b32 s87, s87, 8
    s_add_u32 s7, s7, s87
    s_add_u32 s7, s7, 561152
    v_lshlrev_b32 v14, 4, v2
    v_lshl_add_u32 v14, v3, 11, v14
    s_lshl_b32 s86, s81, 5
    v_lshlrev_b32 v15, 1, v2
    v_add_u32 v15, s86, v15
    global_load_ushort v15, v15, s[32:33]
La_nw2:
    s_waitcnt lgkmcnt(5)
    v_mfma_f32_16x16x32_bf16 v[56:59], v[80:83], v[40:43], v[56:59]
    v_mfma_f32_16x16x32_bf16 v[60:63], v[84:87], v[40:43], v[60:63]
    ds_read_b128 v[40:43], v20 offset:512
    s_waitcnt lgkmcnt(5)
    v_mfma_f32_16x16x32_bf16 v[56:59], v[88:91], v[44:47], v[56:59]
    v_mfma_f32_16x16x32_bf16 v[60:63], v[92:95], v[44:47], v[60:63]
    ds_read_b128 v[44:47], v21 offset:512
    s_waitcnt lgkmcnt(5)
    v_mfma_f32_16x16x32_bf16 v[56:59], v[96:99], v[48:51], v[56:59]
    v_mfma_f32_16x16x32_bf16 v[60:63], v[100:103], v[48:51], v[60:63]
    ds_read_b128 v[48:51], v22 offset:512
    s_waitcnt lgkmcnt(5)
    v_mfma_f32_16x16x32_bf16 v[56:59], v[104:107], v[52:55], v[56:59]
    v_mfma_f32_16x16x32_bf16 v[60:63], v[108:111], v[52:55], v[60:63]
    ds_read_b128 v[52:55], v23 offset:512
    s_waitcnt lgkmcnt(5)
    v_mfma_f32_16x16x32_bf16 v[56:59], v[112:115], v[32:35], v[56:59]
    v_mfma_f32_16x16x32_bf16 v[60:63], v[116:119], v[32:35], v[60:63]
    ds_read_b128 v[32:35], v20 offset:768
    s_waitcnt lgkmcnt(5)
    v_mfma_f32_16x16x32_bf16 v[56:59], v[120:123], v[36:39], v[56:59]
    v_mfma_f32_16x16x32_bf16 v[60:63], v[124:127], v[36:39], v[60:63]
    ds_read_b128 v[36:39], v21 offset:768
    s_waitcnt lgkmcnt(5)
    v_mfma_f32_16x16x32_bf16 v[56:59], v[128:131], v[40:43], v[56:59]
    v_mfma_f32_16x16x32_bf16 v[60:63], v[132:135], v[40:43], v[60:63]
    ds_read_b128 v[40:43], v22 offset:768
    s_waitcnt lgkmcnt(5)
    v_mfma_f32_16x16x32_bf16 v[56:59], v[136:139], v[44:47], v[56:59]
    v_mfma_f32_16x16x32_bf16 v[60:63], v[140:143], v[44:47], v[60:63]
    ds_read_b128 v[44:47], v23 offset:768
    s_waitcnt lgkmcnt(5)
    v_mfma_f32_16x16x32_bf16 v[56:59], v[144:147], v[48:51], v[56:59]
    v_mfma_f32_16x16x32_bf16 v[60:63], v[148:151], v[48:51], v[60:63]
    s_waitcnt lgkmcnt(4)
    v_mfma_f32_16x16x32_bf16 v[56:59], v[152:155], v[52:55], v[56:59]
    v_mfma_f32_16x16x32_bf16 v[60:63], v[156:159], v[52:55], v[60:63]
    s_waitcnt lgkmcnt(3)
    v_mfma_f32_16x16x32_bf16 v[56:59], v[160:163], v[32:35], v[56:59]
    v_mfma_f32_16x16x32_bf16 v[60:63], v[164:167], v[32:35], v[60:63]
    s_waitcnt lgkmcnt(2)
    v_mfma_f32_16x16x32_bf16 v[56:59], v[168:171], v[36:39], v[56:59]
    v_mfma_f32_16x16x32_bf16 v[60:63], v[172:175], v[36:39], v[60:63]
    s_waitcnt lgkmcnt(1)
    v_mfma_f32_16x16x32_bf16 v[56:59], v[176:179], v[40:43], v[56:59]
    v_mfma_f32_16x16x32_bf16 v[60:63], v[180:183], v[40:43], v[60:63]
    s_waitcnt lgkmcnt(0)
    v_mfma_f32_16x16x32_bf16 v[56:59], v[184:187], v[44:47], v[56:59]
    v_mfma_f32_16x16x32_bf16 v[60:63], v[188:191], v[44:47], v[60:63]
    s_lshl_b32 s86, s77, 12
    v_add_u32 v12, s86, v4
    s_mov_b32 s90, 0
    s_nop 3
    v_max3_f32 v5, v56, v57, v58
    v_max3_f32 v6, v59, v60, v61
    v_max3_f32 v5, v5, v62, v63
    v_max_f32 v5, v5, v6
    v_mov_b32 v6, v5
    s_nop 1
    v_permlane16_swap_b32 v5, v6
    v_max_f32 v5, v5, v6
    v_mov_b32 v6, v5
    s_nop 1
    v_permlane32_swap_b32 v5, v6
    v_max_f32 v5, v5, v6
    ds_write_b32 v9, v5 offset:0
La_m:
    ds_read_b128 v[32:35], v8 offset:0
    s_add_u32 s90, s90, 1
    s_cmp_lt_u32 s90, 320000
    s_cselect_b64 s[92:93], -1, 0
    s_waitcnt lgkmcnt(0)
    v_max3_u32 v6, v32, v33, v34
    v_max_u32 v6, v6, v35
    v_cmp_eq_u32 vcc, -1, v6
    v_max3_f32 v5, v32, v33, v34
    s_and_b64 vcc, vcc, s[92:93]
    s_cbranch_vccnz La_m
    v_max_f32 v5, v5, v35
    s_cmp_lg_u32 s77, 0
    s_cbranch_scc1 La_nhf
    buffer_load_dwordx4 v[48:51], v14, s[44:47], s7 offen sc1
La_nhf:
    v_sub_f32 v56, v56, v5
    v_sub_f32 v57, v57, v5
    v_sub_f32 v58, v58, v5
    v_sub_f32 v59, v59, v5
    v_sub_f32 v60, v60, v5
    v_sub_f32 v61, v61, v5
    v_sub_f32 v62, v62, v5
    v_sub_f32 v63, v63, v5
    v_exp_f32 v56, v56
    v_exp_f32 v57, v57
    v_exp_f32 v58, v58
    v_exp_f32 v59, v59
    v_cvt_pk_bf16_f32 v36, v56, v57
    v_exp_f32 v60, v60
    v_exp_f32 v61, v61
    v_cvt_pk_bf16_f32 v37, v58, v59
    v_exp_f32 v62, v62
    v_exp_f32 v63, v63
    v_cvt_pk_bf16_f32 v38, v60, v61
    s_mov_b32 s90, 0
    v_cvt_pk_bf16_f32 v39, v62, v63
    ds_write_b128 v10, v[36:39] offset:1024
    s_cmp_lg_u32 s76, 3
    s_cbranch_scc1 La_nh
    s_lshl_b32 s88, s78, 9
    s_lshl_b32 s86, s77, 8
    s_add_u32 s88, s88, s86
    s_add_u32 s88, s88, 430080
    v_mov_b32 v44, v5
    v_mov_b32 v46, s80
    s_mov_b64 exec, 0xffff
    buffer_store_dwordx4 v[44:47], v4, s[44:47], s88 offen sc1
    s_mov_b64 exec, -1
La_nh:
La_p:
    ds_read_b128 v[128:131], v12 offset:1024
    ds_read_b128 v[132:135], v12 offset:2048
    ds_read_b128 v[136:139], v12 offset:3072
    ds_read_b128 v[140:143], v12 offset:4096
    s_add_u32 s90, s90, 1
    s_cmp_lt_u32 s90, 320000
    s_cselect_b64 s[92:93], -1, 0
    s_waitcnt lgkmcnt(0)
    v_or3_b32 v40, v128, v132, v136
    v_or_b32 v40, v40, v140
    v_cmp_gt_i32 vcc, 0, v40
    s_nop 0
    s_and_b64 vcc, vcc, s[92:93]
    s_cbranch_vccnz La_p
    v_mfma_f32_16x16x32_bf16 v[144:147], v[128:131], v[192:195], 0
    v_add_f32 v56, v56, v57
    ds_read_b64_tr_b16 v[64:65], v24 offset:0
    ds_read_b64_tr_b16 v[66:67], v24 offset:16384
    v_mfma_f32_16x16x32_bf16 v[148:151], v[128:131], v[196:199], 0
    v_add_f32 v58, v58, v59
    ds_read_b64_tr_b16 v[68:69], v25 offset:0
    ds_read_b64_tr_b16 v[70:71], v25 offset:16384
    v_mfma_f32_16x16x32_bf16 v[152:155], v[128:131], v[200:203], 0
    v_add_f32 v60, v60, v61
    ds_read_b64_tr_b16 v[72:73], v26 offset:0
    ds_read_b64_tr_b16 v[74:75], v26 offset:16384
    v_mfma_f32_16x16x32_bf16 v[156:159], v[128:131], v[204:207], 0
    v_add_f32 v62, v62, v63
    ds_read_b64_tr_b16 v[76:77], v27 offset:0
    ds_read_b64_tr_b16 v[78:79], v27 offset:16384
    v_mfma_f32_16x16x32_bf16 v[160:163], v[128:131], v[208:211], 0
    v_add_f32 v56, v56, v58
    ds_read_b64_tr_b16 v[80:81], v28 offset:0
    ds_read_b64_tr_b16 v[82:83], v28 offset:16384
    v_mfma_f32_16x16x32_bf16 v[164:167], v[128:131], v[212:215], 0
    v_add_f32 v60, v60, v62
    ds_read_b64_tr_b16 v[84:85], v29 offset:0
    ds_read_b64_tr_b16 v[86:87], v29 offset:16384
    v_mfma_f32_16x16x32_bf16 v[168:171], v[128:131], v[216:219], 0
    v_add_f32 v56, v56, v60
    ds_read_b64_tr_b16 v[88:89], v30 offset:0
    ds_read_b64_tr_b16 v[90:91], v30 offset:16384
    v_mfma_f32_16x16x32_bf16 v[172:175], v[128:131], v[220:223], 0
    ds_write_b32 v11, v56 offset:9216
    ds_read_b64_tr_b16 v[92:93], v31 offset:0
    ds_read_b64_tr_b16 v[94:95], v31 offset:16384
    s_cmp_lg_u32 s3, 3
    s_cbranch_scc1 La_s0x
    v_lshlrev_b32 v40, 2, v0
    s_mov_b32 s90, 0
    s_lshl_b32 s88, s78, 3
    s_add_u32 s88, s88, 495616
    v_lshlrev_b32 v42, 10, v0
La_s0:
    ds_read_b32 v44, v40 offset:9216
    ds_read_b32 v45, v40 offset:9472
    ds_read_b32 v46, v40 offset:9728
    ds_read_b32 v47, v40 offset:9984
    s_add_u32 s90, s90, 1
    s_cmp_lt_u32 s90, 320000
    s_cselect_b64 s[92:93], -1, 0
    s_waitcnt lgkmcnt(0)
    v_max3_u32 v41, v44, v45, v46
    v_max_u32 v41, v41, v47
    v_cmp_eq_u32 vcc, -1, v41
    v_add_f32 v44, v44, v45
    s_and_b64 vcc, vcc, s[92:93]
    s_cbranch_vccz La_s0d
    s_sleep 1
    s_branch La_s0
La_s0d:
    v_add_f32 v46, v46, v47
    v_add_f32 v40, v44, v46
    v_mov_b32 v44, v40
    s_nop 1
    v_permlane16_swap_b32 v40, v44
    v_add_f32 v40, v40, v44
    v_mov_b32 v44, v40
    s_nop 1
    v_permlane32_swap_b32 v40, v44
    v_add_f32 v40, v40, v44
    v_mov_b32 v41, s80
    s_mov_b64 exec, 0xffff
    buffer_store_dwordx2 v[40:41], v42, s[44:47], s88 offen sc1
    s_mov_b64 exec, -1
La_s0x:
    v_mfma_f32_16x16x32_bf16 v[144:147], v[132:135], v[224:227], v[144:147]
    ds_read_b64_tr_b16 v[96:97], v24 offset:32768
    ds_read_b64_tr_b16 v[98:99], v24 offset:49152
    v_mfma_f32_16x16x32_bf16 v[148:151], v[132:135], v[228:231], v[148:151]
    ds_read_b64_tr_b16 v[100:101], v25 offset:32768
    ds_read_b64_tr_b16 v[102:103], v25 offset:49152
    v_mfma_f32_16x16x32_bf16 v[152:155], v[132:135], v[232:235], v[152:155]
    ds_read_b64_tr_b16 v[104:105], v26 offset:32768
    ds_read_b64_tr_b16 v[106:107], v26 offset:49152
    v_mfma_f32_16x16x32_bf16 v[156:159], v[132:135], v[236:239], v[156:159]
    ds_read_b64_tr_b16 v[108:109], v27 offset:32768
    ds_read_b64_tr_b16 v[110:111], v27 offset:49152
    v_mfma_f32_16x16x32_bf16 v[160:163], v[132:135], v[240:243], v[160:163]
    ds_read_b64_tr_b16 v[112:113], v28 offset:32768
    ds_read_b64_tr_b16 v[114:115], v28 offset:49152
    v_mfma_f32_16x16x32_bf16 v[164:167], v[132:135], v[244:247], v[164:167]
    ds_read_b64_tr_b16 v[116:117], v29 offset:32768
    ds_read_b64_tr_b16 v[118:119], v29 offset:49152
    v_mfma_f32_16x16x32_bf16 v[168:171], v[132:135], v[248:251], v[168:171]
    ds_read_b64_tr_b16 v[120:121], v30 offset:32768
    ds_read_b64_tr_b16 v[122:123], v30 offset:49152
    v_mfma_f32_16x16x32_bf16 v[172:175], v[132:135], v[252:255], v[172:175]
    ds_read_b64_tr_b16 v[124:125], v31 offset:32768
    ds_read_b64_tr_b16 v[126:127], v31 offset:49152
    s_waitcnt lgkmcnt(15)
    v_mfma_f32_16x16x32_bf16 v[144:147], v[136:139], v[64:67], v[144:147]
    s_waitcnt lgkmcnt(15)
    v_mfma_f32_16x16x32_bf16 v[148:151], v[136:139], v[68:71], v[148:151]
    s_waitcnt lgkmcnt(15)
    v_mfma_f32_16x16x32_bf16 v[152:155], v[136:139], v[72:75], v[152:155]
    s_waitcnt lgkmcnt(15)
    v_mfma_f32_16x16x32_bf16 v[156:159], v[136:139], v[76:79], v[156:159]
    s_waitcnt lgkmcnt(15)
    v_mfma_f32_16x16x32_bf16 v[160:163], v[136:139], v[80:83], v[160:163]
    s_waitcnt lgkmcnt(15)
    v_mfma_f32_16x16x32_bf16 v[164:167], v[136:139], v[84:87], v[164:167]
    s_waitcnt lgkmcnt(15)
    v_mfma_f32_16x16x32_bf16 v[168:171], v[136:139], v[88:91], v[168:171]
    s_waitcnt lgkmcnt(15)
    v_mfma_f32_16x16x32_bf16 v[172:175], v[136:139], v[92:95], v[172:175]
    s_waitcnt lgkmcnt(14)
    v_mfma_f32_16x16x32_bf16 v[144:147], v[140:143], v[96:99], v[144:147]
    s_waitcnt lgkmcnt(12)
    v_mfma_f32_16x16x32_bf16 v[148:151], v[140:143], v[100:103], v[148:151]
    s_waitcnt lgkmcnt(10)
    v_mfma_f32_16x16x32_bf16 v[152:155], v[140:143], v[104:107], v[152:155]
    s_waitcnt lgkmcnt(8)
    v_mfma_f32_16x16x32_bf16 v[156:159], v[140:143], v[108:111], v[156:159]
    s_waitcnt lgkmcnt(6)
    v_mfma_f32_16x16x32_bf16 v[160:163], v[140:143], v[112:115], v[160:163]
    s_waitcnt lgkmcnt(4)
    v_mfma_f32_16x16x32_bf16 v[164:167], v[140:143], v[116:119], v[164:167]
    s_waitcnt lgkmcnt(2)
    v_mfma_f32_16x16x32_bf16 v[168:171], v[140:143], v[120:123], v[168:171]
    s_waitcnt lgkmcnt(0)
    v_mfma_f32_16x16x32_bf16 v[172:175], v[140:143], v[124:127], v[172:175]
    s_nop 4
    v_cvt_pk_bf16_f32 v176, v144, v148
    v_cvt_pk_bf16_f32 v177, v152, v156
    v_cvt_pk_bf16_f32 v178, v160, v164
    v_cvt_pk_bf16_f32 v179, v168, v172
    s_add_u32 s87, s79, 0
    v_and_or_b32 v176, v176, s82, v16
    v_and_or_b32 v177, v177, s82, v17
    v_and_or_b32 v178, v178, s82, v18
    v_and_or_b32 v179, v179, s82, v19
    buffer_store_dwordx4 v[176:179], v7, s[44:47], s87 offen sc1
    v_cvt_pk_bf16_f32 v180, v145, v149
    v_cvt_pk_bf16_f32 v181, v153, v157
    v_cvt_pk_bf16_f32 v182, v161, v165
    v_cvt_pk_bf16_f32 v183, v169, v173
    s_add_u32 s87, s79, 131072
    v_and_or_b32 v180, v180, s82, v16
    v_and_or_b32 v181, v181, s82, v17
    v_and_or_b32 v182, v182, s82, v18
    v_and_or_b32 v183, v183, s82, v19
    buffer_store_dwordx4 v[180:183], v7, s[44:47], s87 offen sc1
    v_cvt_pk_bf16_f32 v184, v146, v150
    v_cvt_pk_bf16_f32 v185, v154, v158
    v_cvt_pk_bf16_f32 v186, v162, v166
    v_cvt_pk_bf16_f32 v187, v170, v174
    s_add_u32 s87, s79, 262144
    v_and_or_b32 v184, v184, s82, v16
    v_and_or_b32 v185, v185, s82, v17
    v_and_or_b32 v186, v186, s82, v18
    v_and_or_b32 v187, v187, s82, v19
    buffer_store_dwordx4 v[184:187], v7, s[44:47], s87 offen sc1
    v_cvt_pk_bf16_f32 v188, v147, v151
    v_cvt_pk_bf16_f32 v189, v155, v159
    v_cvt_pk_bf16_f32 v190, v163, v167
    v_cvt_pk_bf16_f32 v191, v171, v175
    s_add_u32 s87, s79, 393216
    v_and_or_b32 v188, v188, s82, v16
    v_and_or_b32 v189, v189, s82, v17
    v_and_or_b32 v190, v190, s82, v18
    v_and_or_b32 v191, v191, s82, v19
    buffer_store_dwordx4 v[188:191], v7, s[44:47], s87 offen sc1
    s_cmp_lg_u32 s3, 2
    s_cbranch_scc1 La_s1x
    v_lshlrev_b32 v40, 2, v0
    s_mov_b32 s90, 0
    s_lshl_b32 s88, s78, 3
    s_add_u32 s88, s88, 512000
    v_lshlrev_b32 v42, 10, v0
La_s1:
    ds_read_b32 v44, v40 offset:10240
    ds_read_b32 v45, v40 offset:10496
    ds_read_b32 v46, v40 offset:10752
    ds_read_b32 v47, v40 offset:11008
    s_add_u32 s90, s90, 1
    s_cmp_lt_u32 s90, 320000
    s_cselect_b64 s[92:93], -1, 0
    s_waitcnt lgkmcnt(0)
    v_max3_u32 v41, v44, v45, v46
    v_max_u32 v41, v41, v47
    v_cmp_eq_u32 vcc, -1, v41
    v_add_f32 v44, v44, v45
    s_and_b64 vcc, vcc, s[92:93]
    s_cbranch_vccz La_s1d
    s_sleep 1
    s_branch La_s1
La_s1d:
    v_add_f32 v46, v46, v47
    v_add_f32 v40, v44, v46
    v_mov_b32 v44, v40
    s_nop 1
    v_permlane16_swap_b32 v40, v44
    v_add_f32 v40, v40, v44
    v_mov_b32 v44, v40
    s_nop 1
    v_permlane32_swap_b32 v40, v44
    v_add_f32 v40, v40, v44
    v_mov_b32 v41, s80
    s_mov_b64 exec, 0xffff
    buffer_store_dwordx2 v[40:41], v42, s[44:47], s88 offen sc1
    s_mov_b64 exec, -1
La_s1x:
    s_cmp_lg_u32 s77, 0
    s_cbranch_scc1 La_fdone
    s_cmp_ge_u32 s78, 112
    s_cbranch_scc1 La_f3
    v_and_b32 v60, 3, v2
    v_lshrrev_b32 v61, 2, v2
    v_lshl_add_u32 v61, v3, 2, v61
    v_and_b32 v62, 7, v61
    v_lshlrev_b32 v62, 5, v62
    v_lshl_add_u32 v62, v60, 3, v62
    v_lshl_add_u32 v62, v61, 10, v62
    s_lshl_b32 s87, s3, 8
    v_add_u32 v62, s87, v62
    s_lshl_b32 s87, s3, 7
    v_lshlrev_b32 v58, 1, v0
    v_add_u32 v58, s87, v58
    v_lshlrev_b32 v59, 5, v60
    v_lshl_add_u32 v59, v3, 3, v59
    v_add_u32 v59, s87, v59
    v_mov_b32 v57, 0
    s_lshl_b32 s87, s3, 2
    v_mov_b32 v56, s87
    s_mov_b32 s90, 0
    s_waitcnt vmcnt(4)
    s_branch Lgf_31
Lg_29:
    buffer_load_dwordx4 v[48:51], v14, s[44:47], s7 offen offset:0 sc1
    s_waitcnt vmcnt(0)
Lgf_31:
    v_cmp_ne_u32 vcc, s80, v51
    s_cbranch_vccz Lgd_30
    s_add_u32 s90, s90, 1
    s_cmp_lt_u32 s90, 40000
    s_cbranch_scc1 Lg_29
Lgd_30:
    ds_write_b32 v56, v57 offset:512
    v_mov_b32 v56, 0
    v_perm_b32 v51, v50, v49, s8
    v_perm_b32 v51, v51, v48, s9
    v_lshlrev_b32 v15, 16, v15
    v_permlane32_swap_b32 v48, v50
    v_permlane32_swap_b32 v49, v51
    v_add_f32 v48, v48, v50
    v_add_f32 v49, v49, v51
    s_mov_b32 s86, 0x3d372713
    s_nop 0
    v_permlane16_swap_b32 v48, v49
    v_add_f32 v48, v48, v49
    v_cvt_pk_bf16_f32 v48, v48, v48
    v_lshlrev_b32 v48, 16, v48
    v_add_f32 v48, v48, v15
    v_cvt_pk_bf16_f32 v48, v48, v48
    v_lshlrev_b32 v48, 16, v48
    v_mul_f32 v49, v48, v48
    v_fma_f32 v49, v49, s86, 1.0
    v_mul_f32 v49, v49, v48
    v_mul_f32 v49, 0xc0135761, v49
    v_exp_f32 v49, v49
    s_mov_b32 s90, 0
    v_add_f32 v49, 1.0, v49
    v_rcp_f32 v49, v49
    s_lshl_b32 s87, s78, 13
    v_mul_f32 v48, v48, v49
    v_cvt_pk_bf16_f32 v48, v48, v48
    ds_write_b16 v58, v48 offset:49152
    s_lshl_b32 s88, s3, 11
    s_add_u32 s87, s87, s88
    s_add_u32 s87, s87, 2068480
La_f2:
    ds_read_b128 v[52:55], v56 offset:512
    s_add_u32 s90, s90, 1
    s_cmp_lt_u32 s90, 320000
    s_cselect_b64 s[92:93], -1, 0
    s_waitcnt lgkmcnt(0)
    v_or3_b32 v52, v52, v53, v54
    v_or_b32 v52, v52, v55
    v_cmp_ne_u32 vcc, 0, v52
    s_nop 0
    s_and_b64 vcc, vcc, s[92:93]
    s_cbranch_vccnz La_f2
    ds_read_b64 v[50:51], v59 offset:49152
    v_xor_b32 v60, 0, v62
    ds_read_b64_tr_b16 v[64:65], v60 offset:32768
    v_xor_b32 v60, 32, v62
    ds_read_b64_tr_b16 v[66:67], v60 offset:32768
    v_xor_b32 v60, 64, v62
    ds_read_b64_tr_b16 v[68:69], v60 offset:32768
    v_xor_b32 v60, 96, v62
    ds_read_b64_tr_b16 v[70:71], v60 offset:32768
    v_xor_b32 v60, 128, v62
    ds_read_b64_tr_b16 v[72:73], v60 offset:32768
    v_xor_b32 v60, 160, v62
    ds_read_b64_tr_b16 v[74:75], v60 offset:32768
    v_xor_b32 v60, 192, v62
    ds_read_b64_tr_b16 v[76:77], v60 offset:32768
    v_xor_b32 v60, 224, v62
    ds_read_b64_tr_b16 v[78:79], v60 offset:32768
    v_cmp_eq_u32 vcc, 1, v3
    v_cmp_eq_u32 s[92:93], 2, v3
    v_cmp_eq_u32 s[94:95], 3, v3
    s_waitcnt lgkmcnt(0)
    v_mfma_f32_16x16x16_bf16 v[96:99], v[50:51], v[64:65], 0
    v_mfma_f32_16x16x16_bf16 v[100:103], v[50:51], v[66:67], 0
    v_mfma_f32_16x16x16_bf16 v[104:107], v[50:51], v[68:69], 0
    v_mfma_f32_16x16x16_bf16 v[108:111], v[50:51], v[70:71], 0
    v_mfma_f32_16x16x16_bf16 v[112:115], v[50:51], v[72:73], 0
    v_mfma_f32_16x16x16_bf16 v[116:119], v[50:51], v[74:75], 0
    v_mfma_f32_16x16x16_bf16 v[120:123], v[50:51], v[76:77], 0
    v_mfma_f32_16x16x16_bf16 v[124:127], v[50:51], v[78:79], 0
    s_nop 1
    v_cndmask_b32 v96, v96, v100, vcc
    v_cndmask_b32 v97, v97, v101, vcc
    v_cndmask_b32 v98, v98, v102, vcc
    v_cndmask_b32 v99, v99, v103, vcc
    v_cndmask_b32 v96, v96, v104, s[92:93]
    v_cndmask_b32 v97, v97, v105, s[92:93]
    v_cndmask_b32 v98, v98, v106, s[92:93]
    v_cndmask_b32 v99, v99, v107, s[92:93]
    v_cndmask_b32 v96, v96, v108, s[94:95]
    v_cndmask_b32 v97, v97, v109, s[94:95]
    v_cndmask_b32 v98, v98, v110, s[94:95]
    v_cndmask_b32 v99, v99, v111, s[94:95]
    v_perm_b32 v96, v96, v99, s98
    v_perm_b32 v97, v97, v99, s99
    v_perm_b32 v98, v98, v99, s100
    v_mov_b32 v99, s80
    buffer_store_dwordx4 v[96:99], v4, s[44:47], s87 offen offset:0 sc1
    v_cndmask_b32 v112, v112, v116, vcc
    v_cndmask_b32 v113, v113, v117, vcc
    v_cndmask_b32 v114, v114, v118, vcc
    v_cndmask_b32 v115, v115, v119, vcc
    v_cndmask_b32 v112, v112, v120, s[92:93]
    v_cndmask_b32 v113, v113, v121, s[92:93]
    v_cndmask_b32 v114, v114, v122, s[92:93]
    v_cndmask_b32 v115, v115, v123, s[92:93]
    v_cndmask_b32 v112, v112, v124, s[94:95]
    v_cndmask_b32 v113, v113, v125, s[94:95]
    v_cndmask_b32 v114, v114, v126, s[94:95]
    v_cndmask_b32 v115, v115, v127, s[94:95]
    v_perm_b32 v112, v112, v115, s98
    v_perm_b32 v113, v113, v115, s99
    v_perm_b32 v114, v114, v115, s100
    v_mov_b32 v115, s80
    buffer_store_dwordx4 v[112:115], v4, s[44:47], s87 offen offset:1024 sc1
La_f3:
    s_waitcnt vmcnt(2)
La_fdone:
    s_mov_b32 s64, s38
    s_mov_b32 s65, s39
    s_mov_b32 s66, 4096
    s_mov_b32 s67, 0x20000
La_fin:
    v_lshrrev_b32 v9, 2, v0
    v_and_b32 v10, 3, v0
    v_lshlrev_b32 v9, 13, v9
    v_lshl_add_u32 v9, v10, 4, v9
    s_lshl_b32 s88, s3, 17
    s_lshl_b32 s86, s78, 6
    s_add_u32 s88, s88, s86
    s_add_u32 s87, s88, 2068480
    s_add_u32 s88, s88, 1019904
    v_bfe_u32 v14, v0, 2, 2
    s_lshl_b32 s86, s78, 2
    v_add_u32 v14, s86, v14
    v_lshlrev_b32 v14, 1, v14
    v_lshl_add_u32 v15, v10, 10, v14
    s_lshl_b32 s86, s3, 6
    s_add_u32 s86, s86, 13824
    v_lshlrev_b32 v11, 4, v10
    v_add_u32 v11, s86, v11
    v_lshl_add_u32 v12, v3, 2, v11
    v_mov_b32 v20, 0
    v_mov_b32 v21, 0
    v_mov_b32 v22, 0
    v_mov_b32 v23, 0

    global_load_ushort v28, v14, s[36:37]
    global_load_ushort v29, v15, s[16:17]
    s_waitcnt vmcnt(0)
    s_cmp_ge_u32 s3, 7
    s_cbranch_scc1 La_y1
La_y2:
    s_cmp_eq_u32 s3, 0
    s_cbranch_scc1 La_y3
    s_barrier
La_y3:
    s_mov_b32 s90, 0
    buffer_load_dwordx4 v[20:23], v9, s[44:47], s87 offen offset:0 sc1
    s_waitcnt vmcnt(0)
    s_branch Lgf_34
Lg_32:
    s_sleep 6
    buffer_load_dwordx4 v[20:23], v9, s[44:47], s87 offen offset:0 sc1
    s_waitcnt vmcnt(0)
Lgf_34:
    v_cmp_ne_u32 vcc, s80, v23
    s_cbranch_vccz Lgd_33
    s_add_u32 s90, s90, 1
    s_cmp_lt_u32 s90, 40000
    s_cbranch_scc1 Lg_32
Lgd_33:
    v_perm_b32 v23, v22, v21, s8
    v_perm_b32 v23, v23, v20, s9
    s_cmp_lg_u32 s3, 0
    s_cbranch_scc1 La_y4
La_y1:
    s_barrier
La_y4:
    v_add_f32_dpp v20, v20, v20 row_ror:4 row_mask:0xf bank_mask:0xf
    v_add_f32_dpp v21, v21, v21 row_ror:4 row_mask:0xf bank_mask:0xf
    v_add_f32_dpp v22, v22, v22 row_ror:4 row_mask:0xf bank_mask:0xf
    v_add_f32_dpp v23, v23, v23 row_ror:4 row_mask:0xf bank_mask:0xf
    v_add_f32_dpp v20, v20, v20 row_ror:8 row_mask:0xf bank_mask:0xf
    v_add_f32_dpp v21, v21, v21 row_ror:8 row_mask:0xf bank_mask:0xf
    v_add_f32_dpp v22, v22, v22 row_ror:8 row_mask:0xf bank_mask:0xf
    v_add_f32_dpp v23, v23, v23 row_ror:8 row_mask:0xf bank_mask:0xf
    v_mov_b32 v24, v20
    v_mov_b32 v25, v21
    v_mov_b32 v26, v22
    v_mov_b32 v27, v23
    v_permlane16_swap_b32 v20, v24
    v_permlane16_swap_b32 v21, v25
    v_permlane16_swap_b32 v22, v26
    v_permlane16_swap_b32 v23, v27
    v_add_f32 v20, v20, v24
    v_add_f32 v21, v21, v25
    v_add_f32 v22, v22, v26
    v_add_f32 v23, v23, v27
    v_mov_b32 v24, v20
    v_mov_b32 v25, v21
    v_mov_b32 v26, v22
    v_mov_b32 v27, v23
    v_permlane32_swap_b32 v20, v24
    v_permlane32_swap_b32 v21, v25
    v_permlane32_swap_b32 v22, v26
    v_permlane32_swap_b32 v23, v27
    v_add_f32 v20, v20, v24
    v_add_f32 v21, v21, v25
    v_add_f32 v22, v22, v26
    v_add_f32 v23, v23, v27
    s_mov_b64 exec, 15
    ds_write_b128 v11, v[20:23] offset:512
    s_mov_b64 exec, -1
    v_and_b32 v13, 15, v0
    v_lshlrev_b32 v13, 2, v13
    v_add_u32 v13, 13824, v13
    s_waitcnt lgkmcnt(0)
    s_barrier
    ds_read_b32 v40, v13 offset:512
    ds_read_b32 v41, v13 offset:576
    ds_read_b32 v42, v13 offset:640
    ds_read_b32 v43, v13 offset:704
    ds_read_b32 v44, v13 offset:768
    ds_read_b32 v45, v13 offset:832
    ds_read_b32 v46, v13 offset:896
    ds_read_b32 v47, v13 offset:960
    s_waitcnt lgkmcnt(0)
    v_add_f32 v40, v40, v41
    v_add_f32 v42, v42, v43
    v_add_f32 v44, v44, v45
    v_add_f32 v46, v46, v47
    v_add_f32 v40, v40, v42
    v_add_f32 v44, v44, v46
    v_add_f32 v40, v40, v44
    v_cvt_pk_bf16_f32 v40, v40, v40
    v_lshlrev_b32 v40, 16, v40
    v_lshlrev_b32 v28, 16, v28
    v_lshlrev_b32 v29, 16, v29
    v_add_f32 v40, v40, v28
    v_cvt_pk_bf16_f32 v40, v40, v40
    v_lshlrev_b32 v40, 16, v40
    v_mul_f32 v41, 0xbfb8aa3b, v40
    v_exp_f32 v41, v41
    s_nop 0
    v_add_f32 v41, 1.0, v41
    v_rcp_f32 v41, v41
    s_nop 0
    v_mul_f32 v40, v40, v41
    v_cvt_pk_bf16_f32 v40, v40, v40
    v_lshlrev_b32 v40, 16, v40
    s_cmp_lg_u32 s3, 0
    s_cbranch_scc1 La_h0
    v_lshlrev_b32 v30, 8, v0
    s_and_b32 s86, s78, 1
    s_lshl_b32 s86, s86, 7
    s_add_u32 s86, s86, 413696
    s_mov_b32 s90, 0
    buffer_load_dwordx4 v[16:19], v30, s[44:47], s86 offen offset:0 sc1
    s_waitcnt vmcnt(0)
    s_branch Lgf_37
Lg_35:
    buffer_load_dwordx4 v[16:19], v30, s[44:47], s86 offen offset:0 sc1
    s_waitcnt vmcnt(0)
Lgf_37:
    v_cmp_ne_u32 vcc, s80, v16
    s_cbranch_vccz Lgd_36
    s_add_u32 s90, s90, 1
    s_cmp_lt_u32 s90, 40000
    s_cbranch_scc1 Lg_35
Lgd_36:
La_h0:
    s_barrier
    s_mov_b32 s90, 0
    buffer_load_dwordx4 v[16:19], v9, s[44:47], s88 offen offset:0 sc1
    s_waitcnt vmcnt(0)
    s_branch Lgf_40
Lg_38:
    buffer_load_dwordx4 v[16:19], v9, s[44:47], s88 offen offset:0 sc1
    s_waitcnt vmcnt(0)
Lgf_40:
    v_cmp_ne_u32 vcc, s80, v19
    s_cbranch_vccz Lgd_39
    s_add_u32 s90, s90, 1
    s_cmp_lt_u32 s90, 40000
    s_cbranch_scc1 Lg_38
Lgd_39:
    v_perm_b32 v19, v18, v17, s8
    v_perm_b32 v19, v19, v16, s9
    s_nop 0
    v_permlane32_swap_b32 v16, v18
    v_permlane32_swap_b32 v17, v19
    v_add_f32 v16, v16, v18
    v_add_f32 v17, v17, v19
    s_nop 1
    v_permlane16_swap_b32 v16, v17
    v_add_f32 v16, v16, v17
    s_nop 1
    v_add_f32_dpp v16, v16, v16 row_ror:8 row_mask:0xf bank_mask:0xf
    s_nop 1
    v_add_f32_dpp v16, v16, v16 row_ror:4 row_mask:0xf bank_mask:0xf
    ds_write_b32 v12, v16
    s_waitcnt lgkmcnt(0)
    s_barrier
    s_cmp_lg_u32 s3, 0
    s_cbranch_scc1 Lfin
La_o:
    ds_read_b32 v32, v13 offset:0
    ds_read_b32 v33, v13 offset:64
    ds_read_b32 v34, v13 offset:128
    ds_read_b32 v35, v13 offset:192
    ds_read_b32 v36, v13 offset:256
    ds_read_b32 v37, v13 offset:320
    ds_read_b32 v38, v13 offset:384
    ds_read_b32 v39, v13 offset:448
    s_waitcnt lgkmcnt(0)
    v_add_f32 v32, v32, v33
    v_add_f32 v34, v34, v35
    v_add_f32 v36, v36, v37
    v_add_f32 v38, v38, v39
    v_add_f32 v32, v32, v34
    v_add_f32 v36, v36, v38
    v_add_f32 v32, v32, v36
    v_cvt_pk_bf16_f32 v32, v32, v32
    v_lshlrev_b32 v32, 16, v32
    v_mul_f32 v32, v32, v40
    v_cvt_pk_bf16_f32 v32, v32, v32
    v_lshlrev_b32 v32, 16, v32
    v_add_f32 v32, v32, v29
    v_cvt_pk_bf16_f32 v32, v32, v32
    s_mov_b64 exec, 0xffff
    buffer_store_short v32, v15, s[64:67], 0 offen
Lfin:
Lend:
    s_endpgm
    .fill 1024, 4, 0xbf800000
.section .rodata,"a"
.p2align 6
.amdhsa_kernel recurrent_scan__compressed_kv_cla__dense_activation_gelu__decode_kernel
  .amdhsa_next_free_vgpr 256
  .amdhsa_next_free_sgpr 102
  .amdhsa_accum_offset 256
  .amdhsa_group_segment_fixed_size 0
  .amdhsa_kernarg_size 112
  .amdhsa_user_sgpr_count 2
  .amdhsa_user_sgpr_kernarg_segment_ptr 1
  .amdhsa_system_sgpr_workgroup_id_x 1
.end_amdhsa_kernel
```
